```python
import torch

def _softmax(x, axis=-1):
    return torch.softmax(x, dim=axis)
def _gelu(x):
    return torch.nn.functional.gelu(x, approximate="tanh")
def _silu(x):
    return torch.nn.functional.silu(x)
def _sigmoid(x):
    return torch.sigmoid(x)
def _layernorm(x, axis=-1, eps=1e-5):
    m = x.mean(dim=axis, keepdim=True)
    v = x.var(dim=axis, keepdim=True, unbiased=False)
    return (x - m) / torch.sqrt(v + eps)
def _scatter_add(tgt, idx, src, axis=0):
    return tgt.clone().index_add_(axis, idx, src)
def _segment_sum(src, seg, n):
    out = torch.zeros((n,) + src.shape[1:], dtype=src.dtype)
    return out.index_add_(0, seg, src)
def _pad(x, pw):
    flat = tuple(v for pair in reversed(pw) for v in pair)
    return torch.nn.functional.pad(x, flat)

kernel_name = 'gated_mix__linear_attn_block__mixer_s_mlp__prompt'

def setup_inputs():

    _w = (lambda a: (lambda t: t.to(torch.bfloat16) if t.is_floating_point() else t)(torch.as_tensor(a)))
    def _A_setup():
        B, S, D = 1, 2048, 512
        return {
            "x": _w((lambda *s: torch.randn(*s, dtype=torch.bfloat16) * 0.05)(B, S, D)),
            "wqkv": _w((lambda *s: torch.randn(*s, dtype=torch.bfloat16) * 3.2)(D, 3 * D)),
            "wo": _w((lambda *s: torch.randn(*s, dtype=torch.bfloat16) * 1.6)(D, D)),
        }
    _A_in = _A_setup()

    def _B_setup():
        B, S, D, F = 1, 2048, 512, 1792
        return {
            "x":  _w((lambda *s: torch.randn(*s, dtype=torch.bfloat16) * 0.05)(B, S, D)),
            "w1": _w((lambda *s: torch.randn(*s, dtype=torch.bfloat16) * 3.2)(D, D) * (D ** -0.5)),
            "w2": _w((lambda *s: torch.randn(*s, dtype=torch.bfloat16) * 3.2)(D, D) * (D ** -0.5)),
            "w3": _w((lambda *s: torch.randn(*s, dtype=torch.bfloat16) * 3.2)(D, F) * (D ** -0.5)),
            "w4": _w((lambda *s: torch.randn(*s, dtype=torch.bfloat16) * 1.6)(F, D) * (F ** -0.5)),
        }
    _B_in = _B_setup()

    return {
        "A_x": _A_in["x"],
        "A_wqkv": _A_in["wqkv"],
        "A_wo": _A_in["wo"],
        "B_x": _B_in["x"],
        "B_w1": _B_in["w1"],
        "B_w2": _B_in["w2"],
        "B_w3": _B_in["w3"],
        "B_w4": _B_in["w4"],
        "gate_w": _w((lambda *s: torch.randn(*s, dtype=torch.bfloat16) * 0.05)(512) * 16.0),
    }

def reference(A_x, A_wqkv, A_wo, B_x, B_w1, B_w2, B_w3, B_w4, gate_w):
    def _A_ref(x, wqkv, wo):
        B, S, D = x.shape
        H = 32; Dh = D // H
        qkv = (lambda x, *d: x.permute(*d))((x @ wqkv).reshape(B, S, 3, H, Dh), 2, 0, 3, 1, 4)
        q, k, v = qkv[0], qkv[1], qkv[2]
        phi = lambda t: torch.where(t > 0, t + 1, torch.exp(t)) + 1e-6
        pq, pk = phi(q), phi(k)
        kv = torch.einsum("bhsd,bhse->bhde", pk, v)
        z = torch.einsum("bhsd->bhd", pk)
        num = torch.einsum("bhqd,bhde->bhqe", pq, kv)
        den = torch.einsum("bhqd,bhd->bhq", pq, z)[..., None] + 1e-6
        o = num / den
        return (lambda x, *d: x.permute(*d))(o, 0, 2, 1, 3).reshape(B, S, D) @ wo

    def _B_ref(x, w1, w2, w3, w4):
        B, S, D = x.shape
        h = _gelu(_layernorm(x, axis=-1) @ w1)
        c = D // 4
        g0 = _pad(h[:, :, 0*c:1*c], ((0, 0), (1, 0), (0, 0)))[:, :S, :]
        g1 = _pad(h[:, :, 1*c:2*c], ((0, 0), (0, 1), (0, 0)))[:, 1:, :]
        g2 = _pad(h[:, :, 2*c:3*c], ((0, 0), (2, 0), (0, 0)))[:, :S, :]
        g3 = _pad(h[:, :, 3*c:   ], ((0, 0), (0, 2), (0, 0)))[:, 2:, :]
        hs = torch.concatenate([g0, g1, g2, g3], axis=-1) @ w2
        x1 = x + hs
        h2 = _gelu(_layernorm(x1, axis=-1) @ w3) @ w4
        return x1 + h2

    x = A_x
    g = _sigmoid((x * gate_w).sum(-1, keepdims=True))
    a = _A_ref(x, A_wqkv, A_wo)
    b = _B_ref(x, B_w1, B_w2, B_w3, B_w4)
    return g * a + (1 - g) * b
```

```asm
; @launch grid=(256,1,1) block=(256,1,1) lds=163840
.amdgcn_target "amdgcn-amd-amdhsa--gfx950"
.text
.globl gated_mix__linear_attn_block__mixer_s_mlp__prompt_kernel
.p2align 8
.type gated_mix__linear_attn_block__mixer_s_mlp__prompt_kernel,@function
gated_mix__linear_attn_block__mixer_s_mlp__prompt_kernel:
    s_cmp_ge_u32 s2, 256
    s_cbranch_scc1 L_end
    s_getpc_b64 s[56:57]
L_pc:
    s_mov_b32 s88, s56
    s_mov_b32 s89, s57
    s_load_dwordx16 s[64:79], s[0:1], 0
    s_load_dwordx8 s[80:87], s[0:1], 64
    v_lshlrev_b32 v30, 7, v0
    v_min_u32 v30, L_codeend-L_pc-4, v30
    v_mov_b32 v31, s57
    v_add_co_u32 v30, vcc, s56, v30
    s_nop 1
    v_addc_co_u32 v31, vcc, 0, v31, vcc
    global_load_dword v27, v[30:31], off
    v_lshlrev_b32 v30, 7, v0
    v_add_u32 v30, 32768, v30
    v_min_u32 v30, L_codeend-L_pc-4, v30
    v_mov_b32 v31, s57
    v_add_co_u32 v30, vcc, s56, v30
    s_nop 1
    v_addc_co_u32 v31, vcc, 0, v31, vcc
    global_load_dword v27, v[30:31], off
    v_and_b32 v1, 63, v0
    v_lshrrev_b32 v54, 6, v0
    s_nop 0
    v_readfirstlane_b32 s48, v54
    v_and_b32 v2, 31, v1
    v_lshrrev_b32 v3, 5, v1
    v_lshlrev_b32 v4, 4, v1
    v_lshlrev_b32 v5, 7, v1
    s_and_b32 s58, s2, 7
    s_lshr_b32 s59, s2, 3
    s_lshr_b32 s60, s59, 3
    s_lshl_b32 s49, s58, 2
    s_add_u32 s49, s49, s60
    s_and_b32 s50, s59, 7
    s_lshr_b32 s51, s49, 1
    s_and_b32 s52, s59, 15
    s_lshr_b32 s90, s48, 1
    s_and_b32 s91, s48, 1
    s_mov_b32 s92, s59
    s_getreg_b32 s55, hwreg(HW_REG_XCC_ID, 0, 4)
    s_lshr_b32 s58, s50, 1
    s_lshr_b32 s59, s58, 1
    s_add_u32 s59, s59, 1
    s_sub_u32 s60, 0, s59
    s_bitcmp1_b32 s58, 0
    s_cselect_b32 s94, s60, s59
    s_lshl_b32 s60, s49, 6
    s_sub_u32 s60, s60, 2
    v_and_b32 v54, 3, v1
    v_lshrrev_b32 v55, 4, v1
    v_xor_b32 v54, v54, v55
    v_and_b32 v54, 3, v54
    v_lshlrev_b32 v54, 4, v54
    v_lshrrev_b32 v55, 2, v1
    v_add_u32 v55, s60, v55
    v_add_u32 v56, 0, v55
    v_max_i32 v56, 0, v56
    v_min_i32 v56, 2047, v56
    v_lshlrev_b32 v56, 10, v56
    v_add_u32 v56, v56, v54
    v_mov_b32 v22, v56
    v_add_u32 v56, 16, v55
    v_max_i32 v56, 0, v56
    v_min_i32 v56, 2047, v56
    v_lshlrev_b32 v56, 10, v56
    v_add_u32 v56, v56, v54
    v_subrev_u32 v23, 1024, v56
    v_add_u32 v56, 32, v55
    v_max_i32 v56, 0, v56
    v_min_i32 v56, 2047, v56
    v_lshlrev_b32 v56, 10, v56
    v_add_u32 v56, v56, v54
    v_subrev_u32 v24, 2048, v56
    v_add_u32 v56, 48, v55
    v_max_i32 v56, 0, v56
    v_min_i32 v56, 2047, v56
    v_lshlrev_b32 v56, 10, v56
    v_add_u32 v56, v56, v54
    v_subrev_u32 v25, 3072, v56
    v_add_u32 v56, 64, v55
    v_max_i32 v56, 0, v56
    v_min_i32 v56, 2047, v56
    v_lshlrev_b32 v56, 10, v56
    v_add_u32 v56, v56, v54
    v_mov_b32 v26, v56
    v_lshrrev_b32 v54, 3, v1
    v_mul_u32_u24 v54, 1024, v54
    v_lshrrev_b32 v55, 2, v1
    v_lshrrev_b32 v56, 4, v1
    v_xor_b32 v55, v55, v56
    v_and_b32 v55, 1, v55
    v_lshlrev_b32 v55, 6, v55
    v_and_b32 v56, 3, v1
    v_lshlrev_b32 v56, 4, v56
    v_add3_u32 v10, v54, v55, v56
    v_add_u32 v11, 7168, v10
    v_add_u32 v12, 14336, v10
    v_add_u32 v13, 21504, v10
    v_lshrrev_b32 v54, 3, v1
    v_mul_u32_u24 v54, 3072, v54
    v_lshrrev_b32 v55, 2, v1
    v_lshrrev_b32 v56, 4, v1
    v_xor_b32 v55, v55, v56
    v_and_b32 v55, 1, v55
    v_lshlrev_b32 v55, 6, v55
    v_and_b32 v56, 3, v1
    v_lshlrev_b32 v56, 4, v56
    v_add3_u32 v18, v54, v55, v56
    v_add_u32 v19, 23552, v18
    v_add_u32 v20, 47104, v18
    v_add_u32 v21, 70656, v18
    s_cmp_eq_u32 s48, 3
    s_cselect_b64 vcc, -1, 0
    v_cndmask_b32 v18, v18, v10, vcc
    v_cndmask_b32 v19, v19, v11, vcc
    v_cndmask_b32 v20, v20, v12, vcc
    v_cndmask_b32 v21, v21, v13, vcc
    s_waitcnt lgkmcnt(0)
    s_mov_b32 s4, s64
    s_mov_b32 s5, s65
    s_mov_b32 s6, 2097152
    s_mov_b32 s7, 0x20000
    s_mov_b32 s8, s66
    s_mov_b32 s9, s67
    s_mov_b32 s10, 1572864
    s_mov_b32 s11, 0x20000
    s_mov_b32 s20, s72
    s_mov_b32 s21, s73
    s_mov_b32 s22, 524288
    s_mov_b32 s23, 0x20000
    s_mov_b32 s40, s86
    s_mov_b32 s41, s87
    s_mov_b32 s42, 268435456
    s_mov_b32 s43, 0x20000
    s_mov_b32 s44, s80
    s_mov_b32 s45, s81
    s_mov_b32 s46, 1024
    s_mov_b32 s47, 0x20000
    s_mov_b32 s24, s74
    s_mov_b32 s25, s75
    s_mov_b32 s26, 524288
    s_mov_b32 s27, 0x20000
    s_mov_b32 s12, s68
    s_mov_b32 s13, s69
    s_mov_b32 s14, 524288
    s_mov_b32 s15, 0x20000
    s_mov_b32 s28, s76
    s_mov_b32 s29, s77
    s_mov_b32 s30, 1835008
    s_mov_b32 s31, 0x20000
    s_mov_b32 s32, s78
    s_mov_b32 s33, s79
    s_mov_b32 s34, 1835008
    s_mov_b32 s35, 0x20000
    s_mov_b32 s36, s82
    s_mov_b32 s37, s83
    s_mov_b32 s38, 2097152
    s_mov_b32 s39, 0x20000
    s_load_dword s53, s[40:41], 0
    s_mov_b32 s67, s92
    s_cmp_eq_u32 s48, 3
    s_cselect_b32 s16, s20, s8
    s_cselect_b32 s17, s21, s9
    s_cselect_b32 s18, s22, s10
    s_cselect_b32 s19, s23, s11
    s_lshl_b32 s58, s48, 10
    s_cmp_eq_u32 s48, 3
    s_cselect_b32 s58, 0, s58
    s_mov_b32 s66, 98304
    s_cselect_b32 s66, 32768, s66
    s_lshl_b32 s59, s50, 7
    s_add_u32 s65, s58, s59
    s_lshl_b32 s68, s48, 12
    s_mul_i32 s69, s48, 4352
    s_lshl_b32 s70, s48, 6
    s_mov_b32 m0, 151552
    s_nop 0
    buffer_load_dwordx4 v4, s[44:47], 0 offen lds
    s_add_u32 m0, s68, 69632
    s_mov_b32 s64, s65
    s_add_u32 s65, s65, s66
    buffer_load_dwordx4 v18, s[16:19], s64 offen lds
    buffer_load_dwordx4 v19, s[16:19], s64 offen offset:1024 lds
    buffer_load_dwordx4 v20, s[16:19], s64 offen offset:2048 lds
    buffer_load_dwordx4 v21, s[16:19], s64 offen offset:3072 lds
    s_add_u32 m0, s69, 0
    s_add_u32 s64, s70, 0
    buffer_load_dwordx4 v22, s[4:7], s64 offen lds
    buffer_load_dwordx4 v23, s[4:7], s64 offen offset:1024 lds
    buffer_load_dwordx4 v24, s[4:7], s64 offen offset:2048 lds
    buffer_load_dwordx4 v25, s[4:7], s64 offen offset:3072 lds
    s_add_u32 m0, s69, 4096
    s_mov_b64 exec, 0xffff
    buffer_load_dwordx4 v26, s[4:7], s64 offen lds
    s_mov_b64 exec, -1
    s_lshl_b32 s64, s2, 2
    s_add_u32 s64, s64, s48
    s_mov_b32 s84, s8
    s_mov_b32 s85, s9
    s_mov_b32 s86, 1572864
    s_mov_b32 s87, 0x20000
    s_mov_b32 s61, 0
    s_cmp_ge_u32 s64, 384
    s_cselect_b32 s84, s4, s84
    s_cselect_b32 s85, s5, s85
    s_cselect_b32 s86, 2097152, s86
    s_cselect_b32 s61, 384, s61
    s_cmp_ge_u32 s64, 896
    s_cselect_b32 s84, s20, s84
    s_cselect_b32 s85, s21, s85
    s_cselect_b32 s86, 524288, s86
    s_cselect_b32 s61, 896, s61
    s_sub_u32 s64, s64, s61
    s_mul_i32 s64, s64, 4096
    s_mov_b32 exec_lo, -1
    s_mov_b32 exec_hi, 0
    buffer_load_dword v27, v5, s[84:87], s64 offen
    s_mov_b64 exec, -1
    s_lshl_b32 s64, s2, 2
    s_add_u32 s64, s64, s48
    s_mov_b32 s84, s24
    s_mov_b32 s85, s25
    s_mov_b32 s86, 524288
    s_mov_b32 s87, 0x20000
    s_mov_b32 s61, 0
    s_sub_u32 s64, s64, s61
    s_mul_i32 s64, s64, 512
    s_mov_b64 exec, 0xf
    buffer_load_dword v27, v5, s[84:87], s64 offen
    s_mov_b64 exec, -1
    v_and_b32 v54, 15, v1
    v_lshrrev_b32 v54, 2, v54
    v_and_b32 v55, 3, v1
    v_lshlrev_b32 v55, 3, v55
    v_lshrrev_b32 v56, 4, v1
    v_and_b32 v56, 1, v56
    v_lshlrev_b32 v56, 5, v56
    v_add_u32 v55, v55, v56
    v_lshrrev_b32 v56, 1, v54
    v_lshlrev_b32 v57, 7, v54
    v_add_u32 v55, v55, v57
    v_xor_b32 v57, 0, v56
    v_lshlrev_b32 v57, 6, v57
    v_add_u32 v57, v57, v55
    v_lshlrev_b32 v58, 10, v3
    v_add_u32 v6, v57, v58
    v_lshlrev_b32 v58, 9, v3
    v_add_u32 v8, v57, v58
    v_xor_b32 v57, 1, v56
    v_lshlrev_b32 v57, 6, v57
    v_add_u32 v57, v57, v55
    v_lshlrev_b32 v58, 10, v3
    v_add_u32 v7, v57, v58
    v_lshlrev_b32 v58, 9, v3
    v_add_u32 v9, v57, v58
    v_lshrrev_b32 v54, 3, v1
    v_mul_u32_u24 v54, 3584, v54
    v_lshrrev_b32 v55, 2, v1
    v_lshrrev_b32 v56, 4, v1
    v_xor_b32 v55, v55, v56
    v_and_b32 v55, 1, v55
    v_lshlrev_b32 v55, 6, v55
    v_and_b32 v56, 3, v1
    v_lshlrev_b32 v56, 4, v56
    v_add3_u32 v14, v54, v55, v56
    v_add_u32 v15, 27648, v14
    v_add_u32 v16, 55296, v14
    v_add_u32 v17, 82944, v14
    s_add_u32 m0, s68, 86016
    s_mov_b32 s64, s65
    s_add_u32 s65, s65, s66
    buffer_load_dwordx4 v18, s[16:19], s64 offen lds
    buffer_load_dwordx4 v19, s[16:19], s64 offen offset:1024 lds
    buffer_load_dwordx4 v20, s[16:19], s64 offen offset:2048 lds
    buffer_load_dwordx4 v21, s[16:19], s64 offen offset:3072 lds
    s_mov_b32 s44, s28
    s_mov_b32 s45, s29
    s_mov_b32 s46, s30
    s_mov_b32 s47, s31
    s_cmp_ge_u32 s52, 14
    s_cselect_b32 s30, 0, s30
    s_mov_b32 s72, 0x3fb8aa3b
    s_mov_b32 s73, 0x3fb8aa3b
    s_mov_b32 s74, 0xbdd2d3e8
    s_mov_b32 s75, 0xbdd2d3e8
    s_mov_b32 s76, 0x358637bd
    s_mov_b32 s77, 0x358637bd
    s_mov_b32 s78, 0x3f803f80
    v_mov_b32 v28, 0xc0135761
    v_mov_b32 v29, 0xc0135761
    s_waitcnt lgkmcnt(0)
    s_mul_i32 s53, s53, 1664525
    s_add_u32 s53, s53, 1013904223
    s_cmp_lg_u32 s48, 0
    s_cbranch_scc1 Lpub01
    s_lshl_b32 s58, s51, 7
    s_lshl_b32 s59, s52, 2
    s_add_u32 s58, s58, s59
    s_add_u32 s58, s58, 4096
    s_and_b32 s59, s53, 0xfffffff0
    s_or_b32 s59, s59, s55
    v_mov_b32 v54, s59
    v_mov_b32 v55, 0
    v_cmp_eq_u32 vcc, 0, v1
    s_nop 1
    s_and_saveexec_b64 s[62:63], vcc
    buffer_store_dword v54, v55, s[40:43], s58 offen sc1
    s_mov_b64 exec, s[62:63]
Lpub01:
    s_xor_b32 s56, s90, s91
    s_lshl_b32 s58, s90, 5
    s_add_u32 s58, s58, 2
    v_add_u32 v54, s58, v2
    v_lshrrev_b32 v55, 2, v54
    v_and_b32 v55, 3, v55
    v_lshlrev_b32 v54, 6, v54
    s_xor_b32 s59, s56, 0
    s_lshl_b32 s59, s59, 1
    v_add_u32 v56, s59, v3
    v_xor_b32 v56, v56, v55
    v_lshlrev_b32 v56, 4, v56
    v_add_u32 v38, v54, v56
    s_xor_b32 s59, s56, 1
    s_lshl_b32 s59, s59, 1
    v_add_u32 v56, s59, v3
    v_xor_b32 v56, v56, v55
    v_lshlrev_b32 v56, 4, v56
    v_add_u32 v39, v54, v56
    s_lshl_b32 s58, s90, 5
    s_add_u32 s58, s58, 2
    s_sub_u32 s58, s58, s94
    v_add_u32 v54, s58, v2
    v_lshrrev_b32 v55, 2, v54
    v_and_b32 v55, 3, v55
    v_lshlrev_b32 v54, 6, v54
    s_xor_b32 s59, s56, 0
    s_lshl_b32 s59, s59, 1
    v_add_u32 v56, s59, v3
    v_xor_b32 v56, v56, v55
    v_lshlrev_b32 v56, 4, v56
    v_add_u32 v40, v54, v56
    s_xor_b32 s59, s56, 1
    s_lshl_b32 s59, s59, 1
    v_add_u32 v56, s59, v3
    v_xor_b32 v56, v56, v55
    v_lshlrev_b32 v56, 4, v56
    v_add_u32 v41, v54, v56
    s_cmp_eq_u32 s91, 0
    s_cselect_b64 vcc, -1, 0
    v_cndmask_b32 v54, v7, v6, vcc
    s_xor_b32 s59, s56, 0
    s_lshl_b32 s59, s59, 11
    s_add_u32 s60, s59, 69632
    v_add_u32 v42, s60, v54
    s_add_u32 s60, s59, 118784
    v_add_u32 v43, s60, v54
    s_xor_b32 s59, s56, 1
    s_lshl_b32 s59, s59, 11
    s_add_u32 s60, s59, 69632
    v_add_u32 v44, s60, v54
    s_add_u32 s60, s59, 118784
    v_add_u32 v45, s60, v54
    s_lshl_b32 s59, s56, 5
    s_add_u32 s59, s59, 151552
    v_lshlrev_b32 v46, 4, v3
    v_add_u32 v46, s59, v46
    v_mov_b32 v232, 0
    v_mov_b32 v233, 0
    v_mov_b32 v234, 0
    v_mov_b32 v235, 0
    v_mov_b32 v236, 0
    v_mov_b32 v237, 0
    v_mov_b32 v238, 0
    v_mov_b32 v239, 0
    s_waitcnt vmcnt(11)
    s_waitcnt vmcnt(6)
    s_waitcnt lgkmcnt(0)
    s_barrier
    ds_read_b128 v[128:131], v38 offset:0
    ds_read_b128 v[132:135], v40 offset:0
    s_add_u32 m0, s69, 17408
    s_add_u32 s64, s70, 256
    buffer_load_dwordx4 v22, s[4:7], s64 offen lds
    ds_read_b64_tr_b16 v[136:137], v42 offset:0
    ds_read_b64_tr_b16 v[138:139], v42 offset:512
    buffer_load_dwordx4 v23, s[4:7], s64 offen offset:1024 lds
    ds_read_b64_tr_b16 v[140:141], v42 offset:4096
    ds_read_b64_tr_b16 v[142:143], v42 offset:4608
    buffer_load_dwordx4 v24, s[4:7], s64 offen offset:2048 lds
    ds_read_b64_tr_b16 v[144:145], v42 offset:8192
    ds_read_b64_tr_b16 v[146:147], v42 offset:8704
    buffer_load_dwordx4 v25, s[4:7], s64 offen offset:3072 lds
    ds_read_b64_tr_b16 v[148:149], v42 offset:12288
    ds_read_b64_tr_b16 v[150:151], v42 offset:12800
    s_add_u32 m0, s69, 21504
    s_mov_b64 exec, 0xffff
    buffer_load_dwordx4 v26, s[4:7], s64 offen lds
    s_mov_b64 exec, -1
    ds_read_b128 v[224:227], v46 offset:0
    ds_read_b128 v[152:155], v39 offset:0
    s_add_u32 m0, s68, 102400
    s_mov_b32 s64, s65
    s_add_u32 s65, s65, s66
    buffer_load_dwordx4 v18, s[16:19], s64 offen lds
    ds_read_b128 v[156:159], v41 offset:0
    ds_read_b64_tr_b16 v[160:161], v44 offset:0
    buffer_load_dwordx4 v19, s[16:19], s64 offen offset:1024 lds
    ds_read_b64_tr_b16 v[162:163], v44 offset:512
    ds_read_b64_tr_b16 v[164:165], v44 offset:4096
    buffer_load_dwordx4 v20, s[16:19], s64 offen offset:2048 lds
    ds_read_b64_tr_b16 v[166:167], v44 offset:4608
    ds_read_b64_tr_b16 v[168:169], v44 offset:8192
    ds_read_b64_tr_b16 v[170:171], v44 offset:8704
    ds_read_b64_tr_b16 v[172:173], v44 offset:12288
    ds_read_b64_tr_b16 v[174:175], v44 offset:12800
    s_waitcnt vmcnt(8)
    s_waitcnt lgkmcnt(0)
    s_barrier
    v_mfma_f32_32x32x16_bf16 v[64:79], v[136:139], v[128:131], 0
    ds_read_b128 v[176:179], v38 offset:4352
    ds_read_b128 v[180:183], v40 offset:4352
    buffer_load_dwordx4 v21, s[16:19], s64 offen offset:3072 lds
    ds_read_b64_tr_b16 v[184:185], v42 offset:16384
    v_mfma_f32_32x32x16_bf16 v[80:95], v[128:131], v[140:143], 0
    ds_read_b64_tr_b16 v[186:187], v42 offset:16896
    s_add_u32 m0, s68, 118784
    s_mov_b32 s64, s65
    s_add_u32 s65, s65, s66
    buffer_load_dwordx4 v18, s[16:19], s64 offen lds
    ds_read_b64_tr_b16 v[188:189], v42 offset:20480
    ds_read_b64_tr_b16 v[190:191], v42 offset:20992
    v_mfma_f32_32x32x16_bf16 v[96:111], v[128:131], v[144:147], 0
    buffer_load_dwordx4 v19, s[16:19], s64 offen offset:1024 lds
    ds_read_b64_tr_b16 v[192:193], v42 offset:24576
    ds_read_b64_tr_b16 v[194:195], v42 offset:25088
    v_mfma_f32_32x32x16_bf16 v[112:127], v[148:151], v[132:135], 0
    buffer_load_dwordx4 v20, s[16:19], s64 offen offset:2048 lds
    ds_read_b64_tr_b16 v[196:197], v42 offset:28672
    ds_read_b64_tr_b16 v[198:199], v42 offset:29184
    buffer_load_dwordx4 v21, s[16:19], s64 offen offset:3072 lds
    v_mfma_f32_32x32x16_bf16 v[64:79], v[160:163], v[152:155], v[64:79]
    ds_read_b128 v[228:231], v46 offset:64
    ds_read_b128 v[200:203], v39 offset:4352
    s_add_u32 m0, s68, 135168
    s_mov_b32 s64, s65
    s_add_u32 s65, s65, s66
    buffer_load_dwordx4 v18, s[16:19], s64 offen lds
    ds_read_b128 v[204:207], v41 offset:4352
    v_mfma_f32_32x32x16_bf16 v[80:95], v[152:155], v[164:167], v[80:95]
    ds_read_b64_tr_b16 v[208:209], v44 offset:16384
    buffer_load_dwordx4 v19, s[16:19], s64 offen offset:1024 lds
    ds_read_b64_tr_b16 v[210:211], v44 offset:16896
    v_mfma_f32_32x32x16_bf16 v[96:111], v[152:155], v[168:171], v[96:111]
    ds_read_b64_tr_b16 v[212:213], v44 offset:20480
    buffer_load_dwordx4 v20, s[16:19], s64 offen offset:2048 lds
    ds_read_b64_tr_b16 v[214:215], v44 offset:20992
    ds_read_b64_tr_b16 v[216:217], v44 offset:24576
    v_mfma_f32_32x32x16_bf16 v[112:127], v[172:175], v[156:159], v[112:127]
    ds_read_b64_tr_b16 v[218:219], v44 offset:25088
    ds_read_b64_tr_b16 v[220:221], v44 offset:28672
    ds_read_b64_tr_b16 v[222:223], v44 offset:29184
    v_dot2c_f32_bf16 v232, s78, v132
    v_dot2c_f32_bf16 v234, v132, v132
    v_dot2c_f32_bf16 v233, s78, v133
    v_dot2c_f32_bf16 v235, v133, v133
    v_dot2c_f32_bf16 v232, s78, v134
    v_dot2c_f32_bf16 v234, v134, v134
    v_dot2c_f32_bf16 v233, s78, v135
    v_dot2c_f32_bf16 v235, v135, v135
    v_dot2c_f32_bf16 v236, v128, v224
    v_dot2c_f32_bf16 v238, s78, v148
    v_dot2c_f32_bf16 v237, v129, v225
    v_dot2c_f32_bf16 v239, s78, v149
    v_dot2c_f32_bf16 v236, v130, v226
    v_dot2c_f32_bf16 v238, s78, v150
    v_dot2c_f32_bf16 v237, v131, v227
    v_dot2c_f32_bf16 v239, s78, v151
    s_waitcnt vmcnt(7)
    s_waitcnt lgkmcnt(0)
    s_barrier
    v_mfma_f32_32x32x16_bf16 v[64:79], v[184:187], v[176:179], v[64:79]
    ds_read_b128 v[128:131], v38 offset:8704
    ds_read_b128 v[132:135], v40 offset:8704
    buffer_load_dwordx4 v21, s[16:19], s64 offen offset:3072 lds
    ds_read_b64_tr_b16 v[136:137], v42 offset:32768
    v_mfma_f32_32x32x16_bf16 v[80:95], v[176:179], v[188:191], v[80:95]
    ds_read_b64_tr_b16 v[138:139], v42 offset:33280
    s_lshl_b32 s64, s67, 2
    s_add_u32 s64, s64, s48
    s_cmp_lt_u32 s64, 96
    s_cselect_b32 s84, s8, s20
    s_cselect_b32 s85, s9, s21
    s_cselect_b32 s86, s10, s22
    s_mov_b32 s87, 0x20000
    s_cselect_b32 s61, 0, 96
    s_sub_u32 s64, s64, s61
    s_lshl_b32 s64, s64, 14
    s_add_u32 s64, s64, 384
    v_lshlrev_b32 v50, 10, v1
    s_mov_b64 exec, 0xffff
    buffer_load_dword v27, v50, s[84:87], s64 offen
    s_mov_b64 exec, -1
    ds_read_b64_tr_b16 v[140:141], v42 offset:36864
    ds_read_b64_tr_b16 v[142:143], v42 offset:37376
    v_mfma_f32_32x32x16_bf16 v[96:111], v[176:179], v[192:195], v[96:111]
    s_add_u32 m0, s68, 69632
    s_mov_b32 s64, s65
    s_add_u32 s65, s65, s66
    buffer_load_dwordx4 v18, s[16:19], s64 offen lds
    ds_read_b64_tr_b16 v[144:145], v42 offset:40960
    ds_read_b64_tr_b16 v[146:147], v42 offset:41472
    v_mfma_f32_32x32x16_bf16 v[112:127], v[196:199], v[180:183], v[112:127]
    buffer_load_dwordx4 v19, s[16:19], s64 offen offset:1024 lds
    ds_read_b64_tr_b16 v[148:149], v42 offset:45056
    ds_read_b64_tr_b16 v[150:151], v42 offset:45568
    buffer_load_dwordx4 v20, s[16:19], s64 offen offset:2048 lds
    v_mfma_f32_32x32x16_bf16 v[64:79], v[208:211], v[200:203], v[64:79]
    ds_read_b128 v[224:227], v46 offset:128
    ds_read_b128 v[152:155], v39 offset:8704
    buffer_load_dwordx4 v21, s[16:19], s64 offen offset:3072 lds
    ds_read_b128 v[156:159], v41 offset:8704
    v_mfma_f32_32x32x16_bf16 v[80:95], v[200:203], v[212:215], v[80:95]
    ds_read_b64_tr_b16 v[160:161], v44 offset:32768
    s_add_u32 m0, s69, 34816
    s_add_u32 s64, s70, 512
    buffer_load_dwordx4 v22, s[4:7], s64 offen lds
    ds_read_b64_tr_b16 v[162:163], v44 offset:33280
    v_mfma_f32_32x32x16_bf16 v[96:111], v[200:203], v[216:219], v[96:111]
    ds_read_b64_tr_b16 v[164:165], v44 offset:36864
    buffer_load_dwordx4 v23, s[4:7], s64 offen offset:1024 lds
    ds_read_b64_tr_b16 v[166:167], v44 offset:37376
    ds_read_b64_tr_b16 v[168:169], v44 offset:40960
    v_mfma_f32_32x32x16_bf16 v[112:127], v[220:223], v[204:207], v[112:127]
    ds_read_b64_tr_b16 v[170:171], v44 offset:41472
    ds_read_b64_tr_b16 v[172:173], v44 offset:45056
    ds_read_b64_tr_b16 v[174:175], v44 offset:45568
    v_dot2c_f32_bf16 v232, s78, v180
    v_dot2c_f32_bf16 v234, v180, v180
    v_dot2c_f32_bf16 v233, s78, v181
    v_dot2c_f32_bf16 v235, v181, v181
    v_dot2c_f32_bf16 v232, s78, v182
    v_dot2c_f32_bf16 v234, v182, v182
    v_dot2c_f32_bf16 v233, s78, v183
    v_dot2c_f32_bf16 v235, v183, v183
    v_dot2c_f32_bf16 v236, v176, v228
    v_dot2c_f32_bf16 v238, s78, v196
    v_dot2c_f32_bf16 v237, v177, v229
    v_dot2c_f32_bf16 v239, s78, v197
    v_dot2c_f32_bf16 v236, v178, v230
    v_dot2c_f32_bf16 v238, s78, v198
    v_dot2c_f32_bf16 v237, v179, v231
    v_dot2c_f32_bf16 v239, s78, v199
    s_waitcnt vmcnt(11)
    s_waitcnt lgkmcnt(0)
    s_barrier
    v_mfma_f32_32x32x16_bf16 v[64:79], v[136:139], v[128:131], v[64:79]
    ds_read_b128 v[176:179], v38 offset:13056
    ds_read_b128 v[180:183], v40 offset:13056
    buffer_load_dwordx4 v24, s[4:7], s64 offen offset:2048 lds
    ds_read_b64_tr_b16 v[184:185], v43 offset:0
    v_mfma_f32_32x32x16_bf16 v[80:95], v[128:131], v[140:143], v[80:95]
    ds_read_b64_tr_b16 v[186:187], v43 offset:512
    buffer_load_dwordx4 v25, s[4:7], s64 offen offset:3072 lds
    ds_read_b64_tr_b16 v[188:189], v43 offset:4096
    ds_read_b64_tr_b16 v[190:191], v43 offset:4608
    v_mfma_f32_32x32x16_bf16 v[96:111], v[128:131], v[144:147], v[96:111]
    s_add_u32 m0, s69, 38912
    s_mov_b64 exec, 0xffff
    buffer_load_dwordx4 v26, s[4:7], s64 offen lds
    s_mov_b64 exec, -1
    ds_read_b64_tr_b16 v[192:193], v43 offset:8192
    ds_read_b64_tr_b16 v[194:195], v43 offset:8704
    v_mfma_f32_32x32x16_bf16 v[112:127], v[148:151], v[132:135], v[112:127]
    s_add_u32 m0, s68, 86016
    s_mov_b32 s64, s65
    s_add_u32 s65, s65, s66
    buffer_load_dwordx4 v18, s[16:19], s64 offen lds
    ds_read_b64_tr_b16 v[196:197], v43 offset:12288
    ds_read_b64_tr_b16 v[198:199], v43 offset:12800
    buffer_load_dwordx4 v19, s[16:19], s64 offen offset:1024 lds
    v_mfma_f32_32x32x16_bf16 v[64:79], v[160:163], v[152:155], v[64:79]
    ds_read_b128 v[228:231], v46 offset:192
    ds_read_b128 v[200:203], v39 offset:13056
    buffer_load_dwordx4 v20, s[16:19], s64 offen offset:2048 lds
    ds_read_b128 v[204:207], v41 offset:13056
    v_mfma_f32_32x32x16_bf16 v[80:95], v[152:155], v[164:167], v[80:95]
    ds_read_b64_tr_b16 v[208:209], v45 offset:0
    buffer_load_dwordx4 v21, s[16:19], s64 offen offset:3072 lds
    ds_read_b64_tr_b16 v[210:211], v45 offset:512
    v_mfma_f32_32x32x16_bf16 v[96:111], v[152:155], v[168:171], v[96:111]
    ds_read_b64_tr_b16 v[212:213], v45 offset:4096
    s_add_u32 m0, s68, 102400
    s_mov_b32 s64, s65
    s_add_u32 s65, s65, s66
    buffer_load_dwordx4 v18, s[16:19], s64 offen lds
    ds_read_b64_tr_b16 v[214:215], v45 offset:4608
    ds_read_b64_tr_b16 v[216:217], v45 offset:8192
    v_mfma_f32_32x32x16_bf16 v[112:127], v[172:175], v[156:159], v[112:127]
    ds_read_b64_tr_b16 v[218:219], v45 offset:8704
    ds_read_b64_tr_b16 v[220:221], v45 offset:12288
    ds_read_b64_tr_b16 v[222:223], v45 offset:12800
    v_dot2c_f32_bf16 v232, s78, v132
    v_dot2c_f32_bf16 v234, v132, v132
    v_dot2c_f32_bf16 v233, s78, v133
    v_dot2c_f32_bf16 v235, v133, v133
    v_dot2c_f32_bf16 v232, s78, v134
    v_dot2c_f32_bf16 v234, v134, v134
    v_dot2c_f32_bf16 v233, s78, v135
    v_dot2c_f32_bf16 v235, v135, v135
    v_dot2c_f32_bf16 v236, v128, v224
    v_dot2c_f32_bf16 v238, s78, v148
    v_dot2c_f32_bf16 v237, v129, v225
    v_dot2c_f32_bf16 v239, s78, v149
    v_dot2c_f32_bf16 v236, v130, v226
    v_dot2c_f32_bf16 v238, s78, v150
    v_dot2c_f32_bf16 v237, v131, v227
    v_dot2c_f32_bf16 v239, s78, v151
    s_waitcnt vmcnt(15)
    s_waitcnt lgkmcnt(0)
    s_barrier
    v_mfma_f32_32x32x16_bf16 v[64:79], v[184:187], v[176:179], v[64:79]
    ds_read_b128 v[128:131], v38 offset:17408
    ds_read_b128 v[132:135], v40 offset:17408
    buffer_load_dwordx4 v19, s[16:19], s64 offen offset:1024 lds
    ds_read_b64_tr_b16 v[136:137], v43 offset:16384
    v_mfma_f32_32x32x16_bf16 v[80:95], v[176:179], v[188:191], v[80:95]
    ds_read_b64_tr_b16 v[138:139], v43 offset:16896
    buffer_load_dwordx4 v20, s[16:19], s64 offen offset:2048 lds
    ds_read_b64_tr_b16 v[140:141], v43 offset:20480
    ds_read_b64_tr_b16 v[142:143], v43 offset:20992
    v_mfma_f32_32x32x16_bf16 v[96:111], v[176:179], v[192:195], v[96:111]
    buffer_load_dwordx4 v21, s[16:19], s64 offen offset:3072 lds
    ds_read_b64_tr_b16 v[144:145], v43 offset:24576
    ds_read_b64_tr_b16 v[146:147], v43 offset:25088
    v_mfma_f32_32x32x16_bf16 v[112:127], v[196:199], v[180:183], v[112:127]
    s_add_u32 m0, s69, 52224
    s_add_u32 s64, s70, 768
    buffer_load_dwordx4 v22, s[4:7], s64 offen lds
    ds_read_b64_tr_b16 v[148:149], v43 offset:28672
    ds_read_b64_tr_b16 v[150:151], v43 offset:29184
    buffer_load_dwordx4 v23, s[4:7], s64 offen offset:1024 lds
    v_mfma_f32_32x32x16_bf16 v[64:79], v[208:211], v[200:203], v[64:79]
    ds_read_b128 v[224:227], v46 offset:256
    ds_read_b128 v[152:155], v39 offset:17408
    buffer_load_dwordx4 v24, s[4:7], s64 offen offset:2048 lds
    ds_read_b128 v[156:159], v41 offset:17408
    v_mfma_f32_32x32x16_bf16 v[80:95], v[200:203], v[212:215], v[80:95]
    ds_read_b64_tr_b16 v[160:161], v45 offset:16384
    buffer_load_dwordx4 v25, s[4:7], s64 offen offset:3072 lds
    ds_read_b64_tr_b16 v[162:163], v45 offset:16896
    v_mfma_f32_32x32x16_bf16 v[96:111], v[200:203], v[216:219], v[96:111]
    ds_read_b64_tr_b16 v[164:165], v45 offset:20480
    s_add_u32 m0, s69, 56320
    s_mov_b64 exec, 0xffff
    buffer_load_dwordx4 v26, s[4:7], s64 offen lds
    s_mov_b64 exec, -1
    ds_read_b64_tr_b16 v[166:167], v45 offset:20992
    ds_read_b64_tr_b16 v[168:169], v45 offset:24576
    v_mfma_f32_32x32x16_bf16 v[112:127], v[220:223], v[204:207], v[112:127]
    ds_read_b64_tr_b16 v[170:171], v45 offset:25088
    ds_read_b64_tr_b16 v[172:173], v45 offset:28672
    ds_read_b64_tr_b16 v[174:175], v45 offset:29184
    v_dot2c_f32_bf16 v232, s78, v180
    v_dot2c_f32_bf16 v234, v180, v180
    v_dot2c_f32_bf16 v233, s78, v181
    v_dot2c_f32_bf16 v235, v181, v181
    v_dot2c_f32_bf16 v232, s78, v182
    v_dot2c_f32_bf16 v234, v182, v182
    v_dot2c_f32_bf16 v233, s78, v183
    v_dot2c_f32_bf16 v235, v183, v183
    v_dot2c_f32_bf16 v236, v176, v228
    v_dot2c_f32_bf16 v238, s78, v196
    v_dot2c_f32_bf16 v237, v177, v229
    v_dot2c_f32_bf16 v239, s78, v197
    v_dot2c_f32_bf16 v236, v178, v230
    v_dot2c_f32_bf16 v238, s78, v198
    v_dot2c_f32_bf16 v237, v179, v231
    v_dot2c_f32_bf16 v239, s78, v199
    s_waitcnt vmcnt(18)
    s_waitcnt lgkmcnt(0)
    s_barrier
    v_mfma_f32_32x32x16_bf16 v[64:79], v[136:139], v[128:131], v[64:79]
    ds_read_b128 v[176:179], v38 offset:21760
    ds_read_b128 v[180:183], v40 offset:21760
    s_add_u32 m0, s68, 118784
    s_mov_b32 s64, s65
    s_add_u32 s65, s65, s66
    buffer_load_dwordx4 v18, s[16:19], s64 offen lds
    ds_read_b64_tr_b16 v[184:185], v42 offset:0
    v_mfma_f32_32x32x16_bf16 v[80:95], v[128:131], v[140:143], v[80:95]
    ds_read_b64_tr_b16 v[186:187], v42 offset:512
    buffer_load_dwordx4 v19, s[16:19], s64 offen offset:1024 lds
    ds_read_b64_tr_b16 v[188:189], v42 offset:4096
    ds_read_b64_tr_b16 v[190:191], v42 offset:4608
    v_mfma_f32_32x32x16_bf16 v[96:111], v[128:131], v[144:147], v[96:111]
    buffer_load_dwordx4 v20, s[16:19], s64 offen offset:2048 lds
    ds_read_b64_tr_b16 v[192:193], v42 offset:8192
    ds_read_b64_tr_b16 v[194:195], v42 offset:8704
    v_mfma_f32_32x32x16_bf16 v[112:127], v[148:151], v[132:135], v[112:127]
    buffer_load_dwordx4 v21, s[16:19], s64 offen offset:3072 lds
    ds_read_b64_tr_b16 v[196:197], v42 offset:12288
    ds_read_b64_tr_b16 v[198:199], v42 offset:12800
    s_add_u32 m0, s68, 135168
    s_mov_b32 s64, s65
    s_add_u32 s65, s65, s66
    buffer_load_dwordx4 v18, s[16:19], s64 offen lds
    v_mfma_f32_32x32x16_bf16 v[64:79], v[160:163], v[152:155], v[64:79]
    ds_read_b128 v[228:231], v46 offset:320
    ds_read_b128 v[200:203], v39 offset:21760
    buffer_load_dwordx4 v19, s[16:19], s64 offen offset:1024 lds
    ds_read_b128 v[204:207], v41 offset:21760
    v_mfma_f32_32x32x16_bf16 v[80:95], v[152:155], v[164:167], v[80:95]
    ds_read_b64_tr_b16 v[208:209], v44 offset:0
    buffer_load_dwordx4 v20, s[16:19], s64 offen offset:2048 lds
    ds_read_b64_tr_b16 v[210:211], v44 offset:512
    v_mfma_f32_32x32x16_bf16 v[96:111], v[152:155], v[168:171], v[96:111]
    ds_read_b64_tr_b16 v[212:213], v44 offset:4096
    buffer_load_dwordx4 v21, s[16:19], s64 offen offset:3072 lds
    ds_read_b64_tr_b16 v[214:215], v44 offset:4608
    ds_read_b64_tr_b16 v[216:217], v44 offset:8192
    v_mfma_f32_32x32x16_bf16 v[112:127], v[172:175], v[156:159], v[112:127]
    ds_read_b64_tr_b16 v[218:219], v44 offset:8704
    ds_read_b64_tr_b16 v[220:221], v44 offset:12288
    ds_read_b64_tr_b16 v[222:223], v44 offset:12800
    v_dot2c_f32_bf16 v232, s78, v132
    v_dot2c_f32_bf16 v234, v132, v132
    v_dot2c_f32_bf16 v233, s78, v133
    v_dot2c_f32_bf16 v235, v133, v133
    v_dot2c_f32_bf16 v232, s78, v134
    v_dot2c_f32_bf16 v234, v134, v134
    v_dot2c_f32_bf16 v233, s78, v135
    v_dot2c_f32_bf16 v235, v135, v135
    v_dot2c_f32_bf16 v236, v128, v224
    v_dot2c_f32_bf16 v238, s78, v148
    v_dot2c_f32_bf16 v237, v129, v225
    v_dot2c_f32_bf16 v239, s78, v149
    v_dot2c_f32_bf16 v236, v130, v226
    v_dot2c_f32_bf16 v238, s78, v150
    v_dot2c_f32_bf16 v237, v131, v227
    v_dot2c_f32_bf16 v239, s78, v151
    s_waitcnt vmcnt(17)
    s_waitcnt lgkmcnt(0)
    s_barrier
    v_mfma_f32_32x32x16_bf16 v[64:79], v[184:187], v[176:179], v[64:79]
    ds_read_b128 v[128:131], v38 offset:26112
    ds_read_b128 v[132:135], v40 offset:26112
    s_add_u32 m0, s68, 69632
    s_mov_b32 s64, s65
    s_add_u32 s65, s65, s66
    buffer_load_dwordx4 v18, s[16:19], s64 offen lds
    ds_read_b64_tr_b16 v[136:137], v42 offset:16384
    v_mfma_f32_32x32x16_bf16 v[80:95], v[176:179], v[188:191], v[80:95]
    ds_read_b64_tr_b16 v[138:139], v42 offset:16896
    ds_read_b64_tr_b16 v[140:141], v42 offset:20480
    ds_read_b64_tr_b16 v[142:143], v42 offset:20992
    v_mfma_f32_32x32x16_bf16 v[96:111], v[176:179], v[192:195], v[96:111]
    buffer_load_dwordx4 v19, s[16:19], s64 offen offset:1024 lds
    ds_read_b64_tr_b16 v[144:145], v42 offset:24576
    ds_read_b64_tr_b16 v[146:147], v42 offset:25088
    v_mfma_f32_32x32x16_bf16 v[112:127], v[196:199], v[180:183], v[112:127]
    ds_read_b64_tr_b16 v[148:149], v42 offset:28672
    ds_read_b64_tr_b16 v[150:151], v42 offset:29184
    buffer_load_dwordx4 v20, s[16:19], s64 offen offset:2048 lds
    v_mfma_f32_32x32x16_bf16 v[64:79], v[208:211], v[200:203], v[64:79]
    ds_read_b128 v[224:227], v46 offset:384
    ds_read_b128 v[152:155], v39 offset:26112
    ds_read_b128 v[156:159], v41 offset:26112
    ds_read_b64_tr_b16 v[160:161], v44 offset:16384
    v_mfma_f32_32x32x16_bf16 v[80:95], v[200:203], v[212:215], v[80:95]
    buffer_load_dwordx4 v21, s[16:19], s64 offen offset:3072 lds
    ds_read_b64_tr_b16 v[162:163], v44 offset:16896
    ds_read_b64_tr_b16 v[164:165], v44 offset:20480
    v_mfma_f32_32x32x16_bf16 v[96:111], v[200:203], v[216:219], v[96:111]
    ds_read_b64_tr_b16 v[166:167], v44 offset:20992
    ds_read_b64_tr_b16 v[168:169], v44 offset:24576
    v_mfma_f32_32x32x16_bf16 v[112:127], v[220:223], v[204:207], v[112:127]
    ds_read_b64_tr_b16 v[170:171], v44 offset:25088
    ds_read_b64_tr_b16 v[172:173], v44 offset:28672
    ds_read_b64_tr_b16 v[174:175], v44 offset:29184
    v_dot2c_f32_bf16 v232, s78, v180
    v_dot2c_f32_bf16 v234, v180, v180
    v_dot2c_f32_bf16 v233, s78, v181
    v_dot2c_f32_bf16 v235, v181, v181
    v_dot2c_f32_bf16 v232, s78, v182
    v_dot2c_f32_bf16 v234, v182, v182
    v_dot2c_f32_bf16 v233, s78, v183
    v_dot2c_f32_bf16 v235, v183, v183
    v_dot2c_f32_bf16 v236, v176, v228
    v_dot2c_f32_bf16 v238, s78, v196
    v_dot2c_f32_bf16 v237, v177, v229
    v_dot2c_f32_bf16 v239, s78, v197
    v_dot2c_f32_bf16 v236, v178, v230
    v_dot2c_f32_bf16 v238, s78, v198
    v_dot2c_f32_bf16 v237, v179, v231
    v_dot2c_f32_bf16 v239, s78, v199
    s_waitcnt vmcnt(17)
    s_waitcnt lgkmcnt(0)
    s_barrier
    v_mfma_f32_32x32x16_bf16 v[64:79], v[136:139], v[128:131], v[64:79]
    ds_read_b128 v[176:179], v38 offset:30464
    ds_read_b128 v[180:183], v40 offset:30464
    s_add_u32 m0, s68, 86016
    s_mov_b32 s64, s65
    s_add_u32 s65, s65, s66
    buffer_load_dwordx4 v18, s[16:19], s64 offen lds
    ds_read_b64_tr_b16 v[184:185], v42 offset:32768
    v_mfma_f32_32x32x16_bf16 v[80:95], v[128:131], v[140:143], v[80:95]
    ds_read_b64_tr_b16 v[186:187], v42 offset:33280
    ds_read_b64_tr_b16 v[188:189], v42 offset:36864
    ds_read_b64_tr_b16 v[190:191], v42 offset:37376
    v_mfma_f32_32x32x16_bf16 v[96:111], v[128:131], v[144:147], v[96:111]
    buffer_load_dwordx4 v19, s[16:19], s64 offen offset:1024 lds
    ds_read_b64_tr_b16 v[192:193], v42 offset:40960
    ds_read_b64_tr_b16 v[194:195], v42 offset:41472
    v_mfma_f32_32x32x16_bf16 v[112:127], v[148:151], v[132:135], v[112:127]
    ds_read_b64_tr_b16 v[196:197], v42 offset:45056
    ds_read_b64_tr_b16 v[198:199], v42 offset:45568
    buffer_load_dwordx4 v20, s[16:19], s64 offen offset:2048 lds
    v_mfma_f32_32x32x16_bf16 v[64:79], v[160:163], v[152:155], v[64:79]
    ds_read_b128 v[228:231], v46 offset:448
    ds_read_b128 v[200:203], v39 offset:30464
    ds_read_b128 v[204:207], v41 offset:30464
    ds_read_b64_tr_b16 v[208:209], v44 offset:32768
    v_mfma_f32_32x32x16_bf16 v[80:95], v[152:155], v[164:167], v[80:95]
    buffer_load_dwordx4 v21, s[16:19], s64 offen offset:3072 lds
    ds_read_b64_tr_b16 v[210:211], v44 offset:33280
    ds_read_b64_tr_b16 v[212:213], v44 offset:36864
    v_mfma_f32_32x32x16_bf16 v[96:111], v[152:155], v[168:171], v[96:111]
    ds_read_b64_tr_b16 v[214:215], v44 offset:37376
    ds_read_b64_tr_b16 v[216:217], v44 offset:40960
    s_lshl_b32 s64, s67, 2
    s_add_u32 s64, s64, s48
    s_mul_i32 s64, s64, 4096
    s_add_u32 s64, s64, 384
    v_lshlrev_b32 v50, 10, v1
    s_mov_b64 exec, 0xf
    buffer_load_dword v27, v50, s[24:27], s64 offen
    s_mov_b64 exec, -1
    v_mfma_f32_32x32x16_bf16 v[112:127], v[172:175], v[156:159], v[112:127]
    ds_read_b64_tr_b16 v[218:219], v44 offset:41472
    ds_read_b64_tr_b16 v[220:221], v44 offset:45056
    ds_read_b64_tr_b16 v[222:223], v44 offset:45568
    v_dot2c_f32_bf16 v232, s78, v132
    v_dot2c_f32_bf16 v234, v132, v132
    v_dot2c_f32_bf16 v233, s78, v133
    v_dot2c_f32_bf16 v235, v133, v133
    v_dot2c_f32_bf16 v232, s78, v134
    v_dot2c_f32_bf16 v234, v134, v134
    v_dot2c_f32_bf16 v233, s78, v135
    v_dot2c_f32_bf16 v235, v135, v135
    v_dot2c_f32_bf16 v236, v128, v224
    v_dot2c_f32_bf16 v238, s78, v148
    v_dot2c_f32_bf16 v237, v129, v225
    v_dot2c_f32_bf16 v239, s78, v149
    v_dot2c_f32_bf16 v236, v130, v226
    v_dot2c_f32_bf16 v238, s78, v150
    v_dot2c_f32_bf16 v237, v131, v227
    v_dot2c_f32_bf16 v239, s78, v151
    s_waitcnt vmcnt(13)
    s_waitcnt lgkmcnt(0)
    s_barrier
    v_mfma_f32_32x32x16_bf16 v[64:79], v[184:187], v[176:179], v[64:79]
    ds_read_b128 v[128:131], v38 offset:34816
    ds_read_b128 v[132:135], v40 offset:34816
    s_add_u32 m0, s68, 102400
    s_mov_b32 s64, s65
    s_add_u32 s65, s65, s66
    buffer_load_dwordx4 v18, s[16:19], s64 offen lds
    ds_read_b64_tr_b16 v[136:137], v43 offset:0
    v_mfma_f32_32x32x16_bf16 v[80:95], v[176:179], v[188:191], v[80:95]
    ds_read_b64_tr_b16 v[138:139], v43 offset:512
    buffer_load_dwordx4 v19, s[16:19], s64 offen offset:1024 lds
    ds_read_b64_tr_b16 v[140:141], v43 offset:4096
    v_mfma_f32_32x32x16_bf16 v[96:111], v[176:179], v[192:195], v[96:111]
    ds_read_b64_tr_b16 v[142:143], v43 offset:4608
    buffer_load_dwordx4 v20, s[16:19], s64 offen offset:2048 lds
    ds_read_b64_tr_b16 v[144:145], v43 offset:8192
    ds_read_b64_tr_b16 v[146:147], v43 offset:8704
    v_mfma_f32_32x32x16_bf16 v[112:127], v[196:199], v[180:183], v[112:127]
    buffer_load_dwordx4 v21, s[16:19], s64 offen offset:3072 lds
    ds_read_b64_tr_b16 v[148:149], v43 offset:12288
    ds_read_b64_tr_b16 v[150:151], v43 offset:12800
    v_mfma_f32_32x32x16_bf16 v[64:79], v[208:211], v[200:203], v[64:79]
    ds_read_b128 v[224:227], v46 offset:512
    ds_read_b128 v[152:155], v39 offset:34816
    v_mfma_f32_32x32x16_bf16 v[80:95], v[200:203], v[212:215], v[80:95]
    s_lshl_b32 s64, s51, 7
    s_add_u32 s64, s64, 4096
    v_and_b32 v63, 15, v1
    v_lshlrev_b32 v63, 2, v63
    buffer_load_dword v63, v63, s[40:43], s64 offen sc1
    ds_read_b128 v[156:159], v41 offset:34816
    ds_read_b64_tr_b16 v[160:161], v45 offset:0
    ds_read_b64_tr_b16 v[162:163], v45 offset:512
    v_mfma_f32_32x32x16_bf16 v[96:111], v[200:203], v[216:219], v[96:111]
    ds_read_b64_tr_b16 v[164:165], v45 offset:4096
    ds_read_b64_tr_b16 v[166:167], v45 offset:4608
    ds_read_b64_tr_b16 v[168:169], v45 offset:8192
    v_mfma_f32_32x32x16_bf16 v[112:127], v[220:223], v[204:207], v[112:127]
    ds_read_b64_tr_b16 v[170:171], v45 offset:8704
    ds_read_b64_tr_b16 v[172:173], v45 offset:12288
    ds_read_b64_tr_b16 v[174:175], v45 offset:12800
    v_dot2c_f32_bf16 v232, s78, v180
    v_dot2c_f32_bf16 v234, v180, v180
    v_dot2c_f32_bf16 v233, s78, v181
    v_dot2c_f32_bf16 v235, v181, v181
    v_dot2c_f32_bf16 v232, s78, v182
    v_dot2c_f32_bf16 v234, v182, v182
    v_dot2c_f32_bf16 v233, s78, v183
    v_dot2c_f32_bf16 v235, v183, v183
    v_dot2c_f32_bf16 v236, v176, v228
    v_dot2c_f32_bf16 v238, s78, v196
    v_dot2c_f32_bf16 v237, v177, v229
    v_dot2c_f32_bf16 v239, s78, v197
    v_dot2c_f32_bf16 v236, v178, v230
    v_dot2c_f32_bf16 v238, s78, v198
    v_dot2c_f32_bf16 v237, v179, v231
    v_dot2c_f32_bf16 v239, s78, v199
    s_waitcnt vmcnt(14)
    s_waitcnt lgkmcnt(0)
    s_barrier
    v_mfma_f32_32x32x16_bf16 v[64:79], v[136:139], v[128:131], v[64:79]
    ds_read_b128 v[176:179], v38 offset:39168
    ds_read_b128 v[180:183], v40 offset:39168
    s_add_u32 m0, s68, 118784
    s_mov_b32 s64, s65
    s_add_u32 s65, s65, s66
    buffer_load_dwordx4 v18, s[16:19], s64 offen lds
    ds_read_b64_tr_b16 v[184:185], v43 offset:16384
    v_mfma_f32_32x32x16_bf16 v[80:95], v[128:131], v[140:143], v[80:95]
    ds_read_b64_tr_b16 v[186:187], v43 offset:16896
    ds_read_b64_tr_b16 v[188:189], v43 offset:20480
    ds_read_b64_tr_b16 v[190:191], v43 offset:20992
    v_mfma_f32_32x32x16_bf16 v[96:111], v[128:131], v[144:147], v[96:111]
    buffer_load_dwordx4 v19, s[16:19], s64 offen offset:1024 lds
    ds_read_b64_tr_b16 v[192:193], v43 offset:24576
    ds_read_b64_tr_b16 v[194:195], v43 offset:25088
    v_mfma_f32_32x32x16_bf16 v[112:127], v[148:151], v[132:135], v[112:127]
    ds_read_b64_tr_b16 v[196:197], v43 offset:28672
    ds_read_b64_tr_b16 v[198:199], v43 offset:29184
    buffer_load_dwordx4 v20, s[16:19], s64 offen offset:2048 lds
    v_mfma_f32_32x32x16_bf16 v[64:79], v[160:163], v[152:155], v[64:79]
    ds_read_b128 v[228:231], v46 offset:576
    ds_read_b128 v[200:203], v39 offset:39168
    ds_read_b128 v[204:207], v41 offset:39168
    ds_read_b64_tr_b16 v[208:209], v45 offset:16384
    v_mfma_f32_32x32x16_bf16 v[80:95], v[152:155], v[164:167], v[80:95]
    buffer_load_dwordx4 v21, s[16:19], s64 offen offset:3072 lds
    ds_read_b64_tr_b16 v[210:211], v45 offset:16896
    ds_read_b64_tr_b16 v[212:213], v45 offset:20480
    v_mfma_f32_32x32x16_bf16 v[96:111], v[152:155], v[168:171], v[96:111]
    ds_read_b64_tr_b16 v[214:215], v45 offset:20992
    ds_read_b64_tr_b16 v[216:217], v45 offset:24576
    v_mfma_f32_32x32x16_bf16 v[112:127], v[172:175], v[156:159], v[112:127]
    ds_read_b64_tr_b16 v[218:219], v45 offset:25088
    ds_read_b64_tr_b16 v[220:221], v45 offset:28672
    ds_read_b64_tr_b16 v[222:223], v45 offset:29184
    v_dot2c_f32_bf16 v232, s78, v132
    v_dot2c_f32_bf16 v234, v132, v132
    v_dot2c_f32_bf16 v233, s78, v133
    v_dot2c_f32_bf16 v235, v133, v133
    v_dot2c_f32_bf16 v232, s78, v134
    v_dot2c_f32_bf16 v234, v134, v134
    v_dot2c_f32_bf16 v233, s78, v135
    v_dot2c_f32_bf16 v235, v135, v135
    v_dot2c_f32_bf16 v236, v128, v224
    v_dot2c_f32_bf16 v238, s78, v148
    v_dot2c_f32_bf16 v237, v129, v225
    v_dot2c_f32_bf16 v239, s78, v149
    v_dot2c_f32_bf16 v236, v130, v226
    v_dot2c_f32_bf16 v238, s78, v150
    v_dot2c_f32_bf16 v237, v131, v227
    v_dot2c_f32_bf16 v239, s78, v151
    s_waitcnt vmcnt(14)
    s_waitcnt lgkmcnt(0)
    s_barrier
    v_mfma_f32_32x32x16_bf16 v[64:79], v[184:187], v[176:179], v[64:79]
    ds_read_b128 v[128:131], v38 offset:43520
    ds_read_b128 v[132:135], v40 offset:43520
    s_add_u32 m0, s68, 135168
    s_mov_b32 s64, s65
    s_add_u32 s65, s65, s66
    buffer_load_dwordx4 v18, s[16:19], s64 offen lds
    ds_read_b64_tr_b16 v[136:137], v42 offset:0
    v_mfma_f32_32x32x16_bf16 v[80:95], v[176:179], v[188:191], v[80:95]
    ds_read_b64_tr_b16 v[138:139], v42 offset:512
    ds_read_b64_tr_b16 v[140:141], v42 offset:4096
    ds_read_b64_tr_b16 v[142:143], v42 offset:4608
    v_mfma_f32_32x32x16_bf16 v[96:111], v[176:179], v[192:195], v[96:111]
    buffer_load_dwordx4 v19, s[16:19], s64 offen offset:1024 lds
    ds_read_b64_tr_b16 v[144:145], v42 offset:8192
    ds_read_b64_tr_b16 v[146:147], v42 offset:8704
    v_mfma_f32_32x32x16_bf16 v[112:127], v[196:199], v[180:183], v[112:127]
    ds_read_b64_tr_b16 v[148:149], v42 offset:12288
    ds_read_b64_tr_b16 v[150:151], v42 offset:12800
    buffer_load_dwordx4 v20, s[16:19], s64 offen offset:2048 lds
    v_mfma_f32_32x32x16_bf16 v[64:79], v[208:211], v[200:203], v[64:79]
    ds_read_b128 v[224:227], v46 offset:640
    ds_read_b128 v[152:155], v39 offset:43520
    ds_read_b128 v[156:159], v41 offset:43520
    v_mfma_f32_32x32x16_bf16 v[80:95], v[200:203], v[212:215], v[80:95]
    ds_read_b64_tr_b16 v[160:161], v44 offset:0
    buffer_load_dwordx4 v21, s[16:19], s64 offen offset:3072 lds
    ds_read_b64_tr_b16 v[162:163], v44 offset:512
    v_mfma_f32_32x32x16_bf16 v[96:111], v[200:203], v[216:219], v[96:111]
    ds_read_b64_tr_b16 v[164:165], v44 offset:4096
    ds_read_b64_tr_b16 v[166:167], v44 offset:4608
    ds_read_b64_tr_b16 v[168:169], v44 offset:8192
    v_mfma_f32_32x32x16_bf16 v[112:127], v[220:223], v[204:207], v[112:127]
    ds_read_b64_tr_b16 v[170:171], v44 offset:8704
    ds_read_b64_tr_b16 v[172:173], v44 offset:12288
    ds_read_b64_tr_b16 v[174:175], v44 offset:12800
    v_dot2c_f32_bf16 v232, s78, v180
    v_dot2c_f32_bf16 v234, v180, v180
    v_dot2c_f32_bf16 v233, s78, v181
    v_dot2c_f32_bf16 v235, v181, v181
    v_dot2c_f32_bf16 v232, s78, v182
    v_dot2c_f32_bf16 v234, v182, v182
    v_dot2c_f32_bf16 v233, s78, v183
    v_dot2c_f32_bf16 v235, v183, v183
    v_dot2c_f32_bf16 v236, v176, v228
    v_dot2c_f32_bf16 v238, s78, v196
    v_dot2c_f32_bf16 v237, v177, v229
    v_dot2c_f32_bf16 v239, s78, v197
    v_dot2c_f32_bf16 v236, v178, v230
    v_dot2c_f32_bf16 v238, s78, v198
    v_dot2c_f32_bf16 v237, v179, v231
    v_dot2c_f32_bf16 v239, s78, v199
    s_waitcnt vmcnt(14)
    s_waitcnt lgkmcnt(0)
    s_barrier
    v_mfma_f32_32x32x16_bf16 v[64:79], v[136:139], v[128:131], v[64:79]
    ds_read_b128 v[176:179], v38 offset:47872
    ds_read_b128 v[180:183], v40 offset:47872
    s_add_u32 m0, s68, 69632
    s_mov_b32 s64, s65
    s_add_u32 s65, s65, s66
    buffer_load_dwordx4 v18, s[16:19], s64 offen lds
    ds_read_b64_tr_b16 v[184:185], v42 offset:16384
    v_mfma_f32_32x32x16_bf16 v[80:95], v[128:131], v[140:143], v[80:95]
    ds_read_b64_tr_b16 v[186:187], v42 offset:16896
    ds_read_b64_tr_b16 v[188:189], v42 offset:20480
    ds_read_b64_tr_b16 v[190:191], v42 offset:20992
    v_mfma_f32_32x32x16_bf16 v[96:111], v[128:131], v[144:147], v[96:111]
    buffer_load_dwordx4 v19, s[16:19], s64 offen offset:1024 lds
    ds_read_b64_tr_b16 v[192:193], v42 offset:24576
    ds_read_b64_tr_b16 v[194:195], v42 offset:25088
    v_mfma_f32_32x32x16_bf16 v[112:127], v[148:151], v[132:135], v[112:127]
    ds_read_b64_tr_b16 v[196:197], v42 offset:28672
    ds_read_b64_tr_b16 v[198:199], v42 offset:29184
    buffer_load_dwordx4 v20, s[16:19], s64 offen offset:2048 lds
    v_mfma_f32_32x32x16_bf16 v[64:79], v[160:163], v[152:155], v[64:79]
    ds_read_b128 v[228:231], v46 offset:704
    ds_read_b128 v[200:203], v39 offset:47872
    ds_read_b128 v[204:207], v41 offset:47872
    ds_read_b64_tr_b16 v[208:209], v44 offset:16384
    v_mfma_f32_32x32x16_bf16 v[80:95], v[152:155], v[164:167], v[80:95]
    buffer_load_dwordx4 v21, s[16:19], s64 offen offset:3072 lds
    ds_read_b64_tr_b16 v[210:211], v44 offset:16896
    ds_read_b64_tr_b16 v[212:213], v44 offset:20480
    v_mfma_f32_32x32x16_bf16 v[96:111], v[152:155], v[168:171], v[96:111]
    ds_read_b64_tr_b16 v[214:215], v44 offset:20992
    ds_read_b64_tr_b16 v[216:217], v44 offset:24576
    v_mfma_f32_32x32x16_bf16 v[112:127], v[172:175], v[156:159], v[112:127]
    ds_read_b64_tr_b16 v[218:219], v44 offset:25088
    ds_read_b64_tr_b16 v[220:221], v44 offset:28672
    ds_read_b64_tr_b16 v[222:223], v44 offset:29184
    v_dot2c_f32_bf16 v232, s78, v132
    v_dot2c_f32_bf16 v234, v132, v132
    v_dot2c_f32_bf16 v233, s78, v133
    v_dot2c_f32_bf16 v235, v133, v133
    v_dot2c_f32_bf16 v232, s78, v134
    v_dot2c_f32_bf16 v234, v134, v134
    v_dot2c_f32_bf16 v233, s78, v135
    v_dot2c_f32_bf16 v235, v135, v135
    v_dot2c_f32_bf16 v236, v128, v224
    v_dot2c_f32_bf16 v238, s78, v148
    v_dot2c_f32_bf16 v237, v129, v225
    v_dot2c_f32_bf16 v239, s78, v149
    v_dot2c_f32_bf16 v236, v130, v226
    v_dot2c_f32_bf16 v238, s78, v150
    v_dot2c_f32_bf16 v237, v131, v227
    v_dot2c_f32_bf16 v239, s78, v151
    s_waitcnt vmcnt(13)
    s_waitcnt lgkmcnt(0)
    s_barrier
    v_mfma_f32_32x32x16_bf16 v[64:79], v[184:187], v[176:179], v[64:79]
    ds_read_b128 v[128:131], v38 offset:52224
    ds_read_b128 v[132:135], v40 offset:52224
    s_add_u32 m0, s68, 86016
    s_lshl_b32 s64, s48, 15
    s_lshl_b32 s61, s50, 7
    s_add_u32 s64, s64, s61
    s_add_u32 s64, s64, 0
    buffer_load_dwordx4 v10, s[24:27], s64 offen lds
    ds_read_b64_tr_b16 v[136:137], v42 offset:32768
    v_mfma_f32_32x32x16_bf16 v[80:95], v[176:179], v[188:191], v[80:95]
    ds_read_b64_tr_b16 v[138:139], v42 offset:33280
    buffer_load_dwordx4 v11, s[24:27], s64 offen offset:1024 lds
    ds_read_b64_tr_b16 v[140:141], v42 offset:36864
    v_mfma_f32_32x32x16_bf16 v[96:111], v[176:179], v[192:195], v[96:111]
    ds_read_b64_tr_b16 v[142:143], v42 offset:37376
    buffer_load_dwordx4 v12, s[24:27], s64 offen offset:2048 lds
    ds_read_b64_tr_b16 v[144:145], v42 offset:40960
    ds_read_b64_tr_b16 v[146:147], v42 offset:41472
    v_mfma_f32_32x32x16_bf16 v[112:127], v[196:199], v[180:183], v[112:127]
    buffer_load_dwordx4 v13, s[24:27], s64 offen offset:3072 lds
    ds_read_b64_tr_b16 v[148:149], v42 offset:45056
    ds_read_b64_tr_b16 v[150:151], v42 offset:45568
    v_mfma_f32_32x32x16_bf16 v[64:79], v[208:211], v[200:203], v[64:79]
    ds_read_b128 v[224:227], v46 offset:768
    ds_read_b128 v[152:155], v39 offset:52224
    v_mfma_f32_32x32x16_bf16 v[80:95], v[200:203], v[212:215], v[80:95]
    s_lshl_b32 s64, s49, 1
    s_add_u32 s64, s64, s90
    s_mul_i32 s64, s64, 32
    s_lshl_b32 s61, s50, 2
    s_add_u32 s64, s64, s61
    s_lshl_b32 s61, s91, 1
    s_add_u32 s64, s64, s61
    s_lshl_b32 s64, s64, 10
    s_add_u32 s64, s64, 1048576
    s_mov_b64 exec, 0xffff
    buffer_load_dword v27, v5, s[40:43], s64 offen
    s_mov_b64 exec, -1
    ds_read_b128 v[156:159], v41 offset:52224
    ds_read_b64_tr_b16 v[160:161], v44 offset:32768
    ds_read_b64_tr_b16 v[162:163], v44 offset:33280
    v_mfma_f32_32x32x16_bf16 v[96:111], v[200:203], v[216:219], v[96:111]
    ds_read_b64_tr_b16 v[164:165], v44 offset:36864
    ds_read_b64_tr_b16 v[166:167], v44 offset:37376
    ds_read_b64_tr_b16 v[168:169], v44 offset:40960
    v_mfma_f32_32x32x16_bf16 v[112:127], v[220:223], v[204:207], v[112:127]
    ds_read_b64_tr_b16 v[170:171], v44 offset:41472
    ds_read_b64_tr_b16 v[172:173], v44 offset:45056
    ds_read_b64_tr_b16 v[174:175], v44 offset:45568
    v_dot2c_f32_bf16 v232, s78, v180
    v_dot2c_f32_bf16 v234, v180, v180
    v_dot2c_f32_bf16 v233, s78, v181
    v_dot2c_f32_bf16 v235, v181, v181
    v_dot2c_f32_bf16 v232, s78, v182
    v_dot2c_f32_bf16 v234, v182, v182
    v_dot2c_f32_bf16 v233, s78, v183
    v_dot2c_f32_bf16 v235, v183, v183
    v_dot2c_f32_bf16 v236, v176, v228
    v_dot2c_f32_bf16 v238, s78, v196
    v_dot2c_f32_bf16 v237, v177, v229
    v_dot2c_f32_bf16 v239, s78, v197
    v_dot2c_f32_bf16 v236, v178, v230
    v_dot2c_f32_bf16 v238, s78, v198
    v_dot2c_f32_bf16 v237, v179, v231
    v_dot2c_f32_bf16 v239, s78, v199
    s_waitcnt vmcnt(13)
    s_waitcnt lgkmcnt(0)
    s_barrier
    v_mfma_f32_32x32x16_bf16 v[64:79], v[136:139], v[128:131], v[64:79]
    ds_read_b128 v[176:179], v38 offset:56576
    ds_read_b128 v[180:183], v40 offset:56576
    s_add_u32 m0, s68, 102400
    s_lshl_b32 s64, s48, 15
    s_lshl_b32 s61, s50, 7
    s_add_u32 s64, s64, s61
    s_add_u32 s64, s64, 131072
    buffer_load_dwordx4 v10, s[24:27], s64 offen lds
    ds_read_b64_tr_b16 v[184:185], v43 offset:0
    v_mfma_f32_32x32x16_bf16 v[80:95], v[128:131], v[140:143], v[80:95]
    ds_read_b64_tr_b16 v[186:187], v43 offset:512
    ds_read_b64_tr_b16 v[188:189], v43 offset:4096
    ds_read_b64_tr_b16 v[190:191], v43 offset:4608
    v_mfma_f32_32x32x16_bf16 v[96:111], v[128:131], v[144:147], v[96:111]
    buffer_load_dwordx4 v11, s[24:27], s64 offen offset:1024 lds
    ds_read_b64_tr_b16 v[192:193], v43 offset:8192
    ds_read_b64_tr_b16 v[194:195], v43 offset:8704
    v_mfma_f32_32x32x16_bf16 v[112:127], v[148:151], v[132:135], v[112:127]
    ds_read_b64_tr_b16 v[196:197], v43 offset:12288
    ds_read_b64_tr_b16 v[198:199], v43 offset:12800
    buffer_load_dwordx4 v12, s[24:27], s64 offen offset:2048 lds
    v_mfma_f32_32x32x16_bf16 v[64:79], v[160:163], v[152:155], v[64:79]
    ds_read_b128 v[228:231], v46 offset:832
    ds_read_b128 v[200:203], v39 offset:56576
    ds_read_b128 v[204:207], v41 offset:56576
    v_mfma_f32_32x32x16_bf16 v[80:95], v[152:155], v[164:167], v[80:95]
    ds_read_b64_tr_b16 v[208:209], v45 offset:0
    buffer_load_dwordx4 v13, s[24:27], s64 offen offset:3072 lds
    ds_read_b64_tr_b16 v[210:211], v45 offset:512
    v_mfma_f32_32x32x16_bf16 v[96:111], v[152:155], v[168:171], v[96:111]
    ds_read_b64_tr_b16 v[212:213], v45 offset:4096
    ds_read_b64_tr_b16 v[214:215], v45 offset:4608
    ds_read_b64_tr_b16 v[216:217], v45 offset:8192
    v_mfma_f32_32x32x16_bf16 v[112:127], v[172:175], v[156:159], v[112:127]
    ds_read_b64_tr_b16 v[218:219], v45 offset:8704
    ds_read_b64_tr_b16 v[220:221], v45 offset:12288
    ds_read_b64_tr_b16 v[222:223], v45 offset:12800
    v_dot2c_f32_bf16 v232, s78, v132
    v_dot2c_f32_bf16 v234, v132, v132
    v_dot2c_f32_bf16 v233, s78, v133
    v_dot2c_f32_bf16 v235, v133, v133
    v_dot2c_f32_bf16 v232, s78, v134
    v_dot2c_f32_bf16 v234, v134, v134
    v_dot2c_f32_bf16 v233, s78, v135
    v_dot2c_f32_bf16 v235, v135, v135
    v_dot2c_f32_bf16 v236, v128, v224
    v_dot2c_f32_bf16 v238, s78, v148
    v_dot2c_f32_bf16 v237, v129, v225
    v_dot2c_f32_bf16 v239, s78, v149
    v_dot2c_f32_bf16 v236, v130, v226
    v_dot2c_f32_bf16 v238, s78, v150
    v_dot2c_f32_bf16 v237, v131, v227
    v_dot2c_f32_bf16 v239, s78, v151
    s_waitcnt vmcnt(13)
    s_waitcnt lgkmcnt(0)
    s_barrier
    v_mfma_f32_32x32x16_bf16 v[64:79], v[184:187], v[176:179], v[64:79]
    ds_read_b128 v[128:131], v38 offset:60928
    ds_read_b128 v[132:135], v40 offset:60928
    s_add_u32 m0, s68, 118784
    s_lshl_b32 s64, s48, 15
    s_lshl_b32 s61, s50, 7
    s_add_u32 s64, s64, s61
    s_add_u32 s64, s64, 262144
    buffer_load_dwordx4 v10, s[24:27], s64 offen lds
    ds_read_b64_tr_b16 v[136:137], v43 offset:16384
    v_mfma_f32_32x32x16_bf16 v[80:95], v[176:179], v[188:191], v[80:95]
    ds_read_b64_tr_b16 v[138:139], v43 offset:16896
    ds_read_b64_tr_b16 v[140:141], v43 offset:20480
    ds_read_b64_tr_b16 v[142:143], v43 offset:20992
    v_mfma_f32_32x32x16_bf16 v[96:111], v[176:179], v[192:195], v[96:111]
    buffer_load_dwordx4 v11, s[24:27], s64 offen offset:1024 lds
    ds_read_b64_tr_b16 v[144:145], v43 offset:24576
    ds_read_b64_tr_b16 v[146:147], v43 offset:25088
    v_mfma_f32_32x32x16_bf16 v[112:127], v[196:199], v[180:183], v[112:127]
    ds_read_b64_tr_b16 v[148:149], v43 offset:28672
    ds_read_b64_tr_b16 v[150:151], v43 offset:29184
    buffer_load_dwordx4 v12, s[24:27], s64 offen offset:2048 lds
    v_mfma_f32_32x32x16_bf16 v[64:79], v[208:211], v[200:203], v[64:79]
    ds_read_b128 v[224:227], v46 offset:896
    ds_read_b128 v[152:155], v39 offset:60928
    ds_read_b128 v[156:159], v41 offset:60928
    ds_read_b64_tr_b16 v[160:161], v45 offset:16384
    v_mfma_f32_32x32x16_bf16 v[80:95], v[200:203], v[212:215], v[80:95]
    buffer_load_dwordx4 v13, s[24:27], s64 offen offset:3072 lds
    ds_read_b64_tr_b16 v[162:163], v45 offset:16896
    ds_read_b64_tr_b16 v[164:165], v45 offset:20480
    v_mfma_f32_32x32x16_bf16 v[96:111], v[200:203], v[216:219], v[96:111]
    ds_read_b64_tr_b16 v[166:167], v45 offset:20992
    ds_read_b64_tr_b16 v[168:169], v45 offset:24576
    v_mfma_f32_32x32x16_bf16 v[112:127], v[220:223], v[204:207], v[112:127]
    ds_read_b64_tr_b16 v[170:171], v45 offset:25088
    ds_read_b64_tr_b16 v[172:173], v45 offset:28672
    ds_read_b64_tr_b16 v[174:175], v45 offset:29184
    v_dot2c_f32_bf16 v232, s78, v180
    v_dot2c_f32_bf16 v234, v180, v180
    v_dot2c_f32_bf16 v233, s78, v181
    v_dot2c_f32_bf16 v235, v181, v181
    v_dot2c_f32_bf16 v232, s78, v182
    v_dot2c_f32_bf16 v234, v182, v182
    v_dot2c_f32_bf16 v233, s78, v183
    v_dot2c_f32_bf16 v235, v183, v183
    v_dot2c_f32_bf16 v236, v176, v228
    v_dot2c_f32_bf16 v238, s78, v196
    v_dot2c_f32_bf16 v237, v177, v229
    v_dot2c_f32_bf16 v239, s78, v197
    v_dot2c_f32_bf16 v236, v178, v230
    v_dot2c_f32_bf16 v238, s78, v198
    v_dot2c_f32_bf16 v237, v179, v231
    v_dot2c_f32_bf16 v239, s78, v199
    s_waitcnt vmcnt(13)
    s_waitcnt lgkmcnt(0)
    s_barrier
    v_mfma_f32_32x32x16_bf16 v[64:79], v[136:139], v[128:131], v[64:79]
    ds_read_b128 v[176:179], v38 offset:65280
    ds_read_b128 v[180:183], v40 offset:65280
    s_add_u32 m0, s68, 135168
    s_lshl_b32 s64, s48, 15
    s_lshl_b32 s61, s50, 7
    s_add_u32 s64, s64, s61
    s_add_u32 s64, s64, 393216
    buffer_load_dwordx4 v10, s[24:27], s64 offen lds
    ds_read_b64_tr_b16 v[184:185], v42 offset:0
    v_mfma_f32_32x32x16_bf16 v[80:95], v[128:131], v[140:143], v[80:95]
    ds_read_b64_tr_b16 v[186:187], v42 offset:512
    ds_read_b64_tr_b16 v[188:189], v42 offset:4096
    ds_read_b64_tr_b16 v[190:191], v42 offset:4608
    v_mfma_f32_32x32x16_bf16 v[96:111], v[128:131], v[144:147], v[96:111]
    buffer_load_dwordx4 v11, s[24:27], s64 offen offset:1024 lds
    ds_read_b64_tr_b16 v[192:193], v42 offset:8192
    ds_read_b64_tr_b16 v[194:195], v42 offset:8704
    v_mfma_f32_32x32x16_bf16 v[112:127], v[148:151], v[132:135], v[112:127]
    ds_read_b64_tr_b16 v[196:197], v42 offset:12288
    ds_read_b64_tr_b16 v[198:199], v42 offset:12800
    buffer_load_dwordx4 v12, s[24:27], s64 offen offset:2048 lds
    v_mfma_f32_32x32x16_bf16 v[64:79], v[160:163], v[152:155], v[64:79]
    ds_read_b128 v[228:231], v46 offset:960
    ds_read_b128 v[200:203], v39 offset:65280
    ds_read_b128 v[204:207], v41 offset:65280
    v_mfma_f32_32x32x16_bf16 v[80:95], v[152:155], v[164:167], v[80:95]
    ds_read_b64_tr_b16 v[208:209], v44 offset:0
    buffer_load_dwordx4 v13, s[24:27], s64 offen offset:3072 lds
    ds_read_b64_tr_b16 v[210:211], v44 offset:512
    v_mfma_f32_32x32x16_bf16 v[96:111], v[152:155], v[168:171], v[96:111]
    ds_read_b64_tr_b16 v[212:213], v44 offset:4096
    ds_read_b64_tr_b16 v[214:215], v44 offset:4608
    ds_read_b64_tr_b16 v[216:217], v44 offset:8192
    v_mfma_f32_32x32x16_bf16 v[112:127], v[172:175], v[156:159], v[112:127]
    ds_read_b64_tr_b16 v[218:219], v44 offset:8704
    ds_read_b64_tr_b16 v[220:221], v44 offset:12288
    ds_read_b64_tr_b16 v[222:223], v44 offset:12800
    v_dot2c_f32_bf16 v232, s78, v132
    v_dot2c_f32_bf16 v234, v132, v132
    v_dot2c_f32_bf16 v233, s78, v133
    v_dot2c_f32_bf16 v235, v133, v133
    v_dot2c_f32_bf16 v232, s78, v134
    v_dot2c_f32_bf16 v234, v134, v134
    v_dot2c_f32_bf16 v233, s78, v135
    v_dot2c_f32_bf16 v235, v135, v135
    v_dot2c_f32_bf16 v236, v128, v224
    v_dot2c_f32_bf16 v238, s78, v148
    v_dot2c_f32_bf16 v237, v129, v225
    v_dot2c_f32_bf16 v239, s78, v149
    v_dot2c_f32_bf16 v236, v130, v226
    v_dot2c_f32_bf16 v238, s78, v150
    v_dot2c_f32_bf16 v237, v131, v227
    v_dot2c_f32_bf16 v239, s78, v151
    s_waitcnt lgkmcnt(0)
    v_mfma_f32_32x32x16_bf16 v[64:79], v[184:187], v[176:179], v[64:79]
    v_mfma_f32_32x32x16_bf16 v[80:95], v[176:179], v[188:191], v[80:95]
    v_mfma_f32_32x32x16_bf16 v[96:111], v[176:179], v[192:195], v[96:111]
    v_mfma_f32_32x32x16_bf16 v[112:127], v[196:199], v[180:183], v[112:127]
    v_mfma_f32_32x32x16_bf16 v[64:79], v[208:211], v[200:203], v[64:79]
    v_mfma_f32_32x32x16_bf16 v[80:95], v[200:203], v[212:215], v[80:95]
    v_mfma_f32_32x32x16_bf16 v[96:111], v[200:203], v[216:219], v[96:111]
    v_mfma_f32_32x32x16_bf16 v[112:127], v[220:223], v[204:207], v[112:127]
    v_dot2c_f32_bf16 v232, s78, v180
    v_dot2c_f32_bf16 v234, v180, v180
    v_dot2c_f32_bf16 v233, s78, v181
    v_dot2c_f32_bf16 v235, v181, v181
    v_dot2c_f32_bf16 v232, s78, v182
    v_dot2c_f32_bf16 v234, v182, v182
    v_dot2c_f32_bf16 v233, s78, v183
    v_dot2c_f32_bf16 v235, v183, v183
    v_dot2c_f32_bf16 v236, v176, v228
    v_dot2c_f32_bf16 v238, s78, v196
    v_dot2c_f32_bf16 v237, v177, v229
    v_dot2c_f32_bf16 v239, s78, v197
    v_dot2c_f32_bf16 v236, v178, v230
    v_dot2c_f32_bf16 v238, s78, v198
    v_dot2c_f32_bf16 v237, v179, v231
    v_dot2c_f32_bf16 v239, s78, v199
L_abend:
    s_lshl_b32 s58, s90, 5
    s_add_u32 s58, s58, 2
    v_add_u32 v54, s58, v2
    v_lshrrev_b32 v55, 2, v54
    v_and_b32 v55, 3, v55
    s_lshl_b32 s58, s50, 1
    s_add_u32 s58, s58, s91
    s_mul_i32 s58, s58, 4352
    v_lshlrev_b32 v54, 6, v54
    v_lshlrev_b32 v56, 3, v3
    v_add3_u32 v54, v54, v56, s58
    v_xor_b32 v56, 0, v55
    v_lshlrev_b32 v56, 4, v56
    v_add_u32 v56, v56, v54
    ds_read_b64 v[30:31], v56
    v_xor_b32 v56, 1, v55
    v_lshlrev_b32 v56, 4, v56
    v_add_u32 v56, v56, v54
    ds_read_b64 v[32:33], v56
    v_xor_b32 v56, 2, v55
    v_lshlrev_b32 v56, 4, v56
    v_add_u32 v56, v56, v54
    ds_read_b64 v[34:35], v56
    v_xor_b32 v56, 3, v55
    v_lshlrev_b32 v56, 4, v56
    v_add_u32 v56, v56, v54
    ds_read_b64 v[36:37], v56
    v_add_f32 v54, v232, v233
    v_add_f32 v55, v234, v235
    v_add_f32 v56, v236, v237
    v_add_f32 v57, v238, v239
    s_lshl_b32 s58, s48, 10
    s_add_u32 s58, s58, 153088
    v_add_u32 v38, s58, v4
    ds_write_b128 v38, v[54:57]
    s_waitcnt lgkmcnt(0)
    s_barrier
    s_lshl_b32 s64, s2, 2
    s_add_u32 s64, s64, s48
    s_mov_b32 s84, s44
    s_mov_b32 s85, s45
    s_mov_b32 s86, 1835008
    s_mov_b32 s87, 0x20000
    s_mov_b32 s61, 0
    s_cmp_ge_u32 s64, 448
    s_cselect_b32 s84, s12, s84
    s_cselect_b32 s85, s13, s85
    s_cselect_b32 s86, 524288, s86
    s_cselect_b32 s61, 448, s61
    s_cmp_ge_u32 s64, 576
    s_cselect_b32 s84, s32, s84
    s_cselect_b32 s85, s33, s85
    s_cselect_b32 s86, 1835008, s86
    s_cselect_b32 s61, 576, s61
    s_sub_u32 s64, s64, s61
    s_mul_i32 s64, s64, 4096
    s_mov_b32 exec_lo, -1
    s_mov_b32 exec_hi, 0
    buffer_load_dword v27, v5, s[84:87], s64 offen
    s_mov_b64 exec, -1
    s_lshl_b32 s64, s48, 13
    s_add_u32 m0, s64, 0
    s_mul_i32 s64, s48, 114688
    s_lshl_b32 s61, s52, 8
    s_add_u32 s64, s64, s61
    s_add_u32 s64, s64, 0
    buffer_load_dwordx4 v14, s[28:31], s64 offen lds
    buffer_load_dwordx4 v15, s[28:31], s64 offen offset:1024 lds
    buffer_load_dwordx4 v16, s[28:31], s64 offen offset:2048 lds
    buffer_load_dwordx4 v17, s[28:31], s64 offen offset:3072 lds
    s_xor_b32 s58, s48, 1
    s_lshl_b32 s58, s58, 10
    s_add_u32 s58, s58, 153088
    v_add_u32 v38, s58, v4
    s_xor_b32 s58, s48, 2
    s_lshl_b32 s58, s58, 10
    s_add_u32 s58, s58, 153088
    v_add_u32 v39, s58, v4
    ds_read_b96 v[128:130], v38
    ds_read_b32 v131, v39 offset:12
    s_waitcnt lgkmcnt(0)
    v_add_f32 v54, v54, v128
    v_add_f32 v55, v55, v129
    v_add_f32 v56, v56, v130
    v_add_f32 v57, v57, v131
    v_mov_b32 v58, v54
    s_nop 1
    v_permlane32_swap_b32 v54, v58
    v_add_f32 v54, v54, v58
    v_mov_b32 v58, v55
    s_nop 1
    v_permlane32_swap_b32 v55, v58
    v_add_f32 v55, v55, v58
    v_mov_b32 v58, v56
    s_nop 1
    v_permlane32_swap_b32 v56, v58
    v_add_f32 v56, v56, v58
    v_mul_f32 v132, 0xbb000000, v54
    v_mul_f32 v58, 0x3b000000, v55
    v_fma_f32 v58, -v132, v132, v58
    v_max_f32 v58, 0, v58
    v_add_f32 v58, 0x3727c5ac, v58
    v_rsq_f32 v134, v58
    v_mul_f32 v56, 0xbfb8aa3b, v56
    v_exp_f32 v56, v56
    s_nop 0
    v_add_f32 v56, 1.0, v56
    v_rcp_f32 v56, v56
    s_lshl_b32 s58, s90, 7
    s_add_u32 s58, s58, 152576
    v_lshlrev_b32 v59, 2, v2
    v_add_u32 v59, s58, v59
    ds_write_b32 v59, v56
    s_lshl_b32 s58, s49, 6
    s_lshl_b32 s59, s90, 5
    s_add_u32 s58, s58, s59
    s_sub_u32 s58, s58, s94
    v_add_u32 v58, s58, v2
    v_cmp_gt_u32 vcc, 2048, v58
    s_nop 1
    v_cndmask_b32 v134, 0, v134, vcc
    v_cvt_pk_bf16_f32 v58, v57, v57
    v_and_b32 v58, 0xffff0000, v58
    v_sub_f32 v58, v57, v58
    v_cvt_pk_bf16_f32 v136, v57, v58
    v_mov_b32 v137, v136
    v_mov_b32 v138, 0
    v_mov_b32 v139, 0
    v_cvt_pk_bf16_f32 v140, v132, v132
    v_and_b32 v58, 0xffff0000, v140
    v_sub_f32 v58, v132, v58
    v_cvt_pk_bf16_f32 v141, v58, v58
    v_mov_b32 v142, 0
    v_mov_b32 v143, 0
    s_nop 1
    v_mfma_f32_32x32x16_bf16 v[112:127], v[136:139], v[140:143], v[112:127]
    s_nop 11
    v_pk_mul_f32 v[112:113], v[112:113], v[134:135] op_sel_hi:[1,0]
    v_pk_mul_f32 v[114:115], v[114:115], v[134:135] op_sel_hi:[1,0]
    v_pk_mul_f32 v[116:117], v[116:117], v[134:135] op_sel_hi:[1,0]
    v_pk_mul_f32 v[118:119], v[118:119], v[134:135] op_sel_hi:[1,0]
    v_pk_mul_f32 v[152:153], v[112:113], v[112:113]
    v_pk_mul_f32 v[154:155], v[114:115], v[114:115]
    v_pk_mul_f32 v[156:157], v[116:117], v[116:117]
    v_pk_mul_f32 v[158:159], v[118:119], v[118:119]
    v_pk_fma_f32 v[152:153], v[152:153], s[74:75], v[28:29]
    v_pk_fma_f32 v[154:155], v[154:155], s[74:75], v[28:29]
    v_pk_fma_f32 v[156:157], v[156:157], s[74:75], v[28:29]
    v_pk_fma_f32 v[158:159], v[158:159], s[74:75], v[28:29]
    v_pk_mul_f32 v[152:153], v[152:153], v[112:113]
    v_pk_mul_f32 v[154:155], v[154:155], v[114:115]
    v_pk_mul_f32 v[156:157], v[156:157], v[116:117]
    v_pk_mul_f32 v[158:159], v[158:159], v[118:119]
    v_exp_f32 v152, v152
    v_exp_f32 v153, v153
    v_exp_f32 v154, v154
    v_exp_f32 v155, v155
    v_exp_f32 v156, v156
    v_exp_f32 v157, v157
    v_exp_f32 v158, v158
    v_exp_f32 v159, v159
    v_pk_add_f32 v[152:153], v[152:153], 1.0 op_sel_hi:[1,0]
    v_pk_add_f32 v[154:155], v[154:155], 1.0 op_sel_hi:[1,0]
    v_pk_add_f32 v[156:157], v[156:157], 1.0 op_sel_hi:[1,0]
    v_pk_add_f32 v[158:159], v[158:159], 1.0 op_sel_hi:[1,0]
    v_rcp_f32 v152, v152
    v_rcp_f32 v153, v153
    v_rcp_f32 v154, v154
    v_rcp_f32 v155, v155
    v_rcp_f32 v156, v156
    v_rcp_f32 v157, v157
    v_rcp_f32 v158, v158
    v_rcp_f32 v159, v159
    v_pk_mul_f32 v[112:113], v[112:113], v[152:153]
    v_pk_mul_f32 v[114:115], v[114:115], v[154:155]
    v_pk_mul_f32 v[116:117], v[116:117], v[156:157]
    v_pk_mul_f32 v[118:119], v[118:119], v[158:159]
    v_cvt_pk_bf16_f32 v144, v112, v113
    v_cvt_pk_bf16_f32 v145, v114, v115
    v_cvt_pk_bf16_f32 v146, v116, v117
    v_cvt_pk_bf16_f32 v147, v118, v119
    s_lshl_b32 s64, s48, 13
    s_add_u32 m0, s64, 4096
    s_mul_i32 s64, s48, 114688
    s_lshl_b32 s61, s52, 8
    s_add_u32 s64, s64, s61
    s_add_u32 s64, s64, 128
    buffer_load_dwordx4 v14, s[28:31], s64 offen lds
    buffer_load_dwordx4 v15, s[28:31], s64 offen offset:1024 lds
    buffer_load_dwordx4 v16, s[28:31], s64 offen offset:2048 lds
    buffer_load_dwordx4 v17, s[28:31], s64 offen offset:3072 lds
    v_pk_mul_f32 v[120:121], v[120:121], v[134:135] op_sel_hi:[1,0]
    v_pk_mul_f32 v[122:123], v[122:123], v[134:135] op_sel_hi:[1,0]
    v_pk_mul_f32 v[124:125], v[124:125], v[134:135] op_sel_hi:[1,0]
    v_pk_mul_f32 v[126:127], v[126:127], v[134:135] op_sel_hi:[1,0]
    v_pk_mul_f32 v[160:161], v[120:121], v[120:121]
    v_pk_mul_f32 v[162:163], v[122:123], v[122:123]
    v_pk_mul_f32 v[164:165], v[124:125], v[124:125]
    v_pk_mul_f32 v[166:167], v[126:127], v[126:127]
    v_pk_fma_f32 v[160:161], v[160:161], s[74:75], v[28:29]
    v_pk_fma_f32 v[162:163], v[162:163], s[74:75], v[28:29]
    v_pk_fma_f32 v[164:165], v[164:165], s[74:75], v[28:29]
    v_pk_fma_f32 v[166:167], v[166:167], s[74:75], v[28:29]
    v_pk_mul_f32 v[160:161], v[160:161], v[120:121]
    v_pk_mul_f32 v[162:163], v[162:163], v[122:123]
    v_pk_mul_f32 v[164:165], v[164:165], v[124:125]
    v_pk_mul_f32 v[166:167], v[166:167], v[126:127]
    v_exp_f32 v160, v160
    v_exp_f32 v161, v161
    v_exp_f32 v162, v162
    v_exp_f32 v163, v163
    v_exp_f32 v164, v164
    v_exp_f32 v165, v165
    v_exp_f32 v166, v166
    v_exp_f32 v167, v167
    v_pk_add_f32 v[160:161], v[160:161], 1.0 op_sel_hi:[1,0]
    v_pk_add_f32 v[162:163], v[162:163], 1.0 op_sel_hi:[1,0]
    v_pk_add_f32 v[164:165], v[164:165], 1.0 op_sel_hi:[1,0]
    v_pk_add_f32 v[166:167], v[166:167], 1.0 op_sel_hi:[1,0]
    v_rcp_f32 v160, v160
    v_rcp_f32 v161, v161
    v_rcp_f32 v162, v162
    v_rcp_f32 v163, v163
    v_rcp_f32 v164, v164
    v_rcp_f32 v165, v165
    v_rcp_f32 v166, v166
    v_rcp_f32 v167, v167
    v_pk_mul_f32 v[120:121], v[120:121], v[160:161]
    v_pk_mul_f32 v[122:123], v[122:123], v[162:163]
    v_pk_mul_f32 v[124:125], v[124:125], v[164:165]
    v_pk_mul_f32 v[126:127], v[126:127], v[166:167]
    v_cvt_pk_bf16_f32 v148, v120, v121
    v_cvt_pk_bf16_f32 v149, v122, v123
    v_cvt_pk_bf16_f32 v150, v124, v125
    v_cvt_pk_bf16_f32 v151, v126, v127
    s_and_b32 s59, s53, 0xfffffff0
    s_mov_b32 s93, 0x40000
    s_lshl_b32 s58, s51, 7
    s_add_u32 s58, s58, 4096
Lpur2:
    v_and_b32 v56, 0xfffffff0, v63
    v_cmp_ne_u32 vcc, s59, v56
    s_nop 4
    s_cbranch_vccz Lpuro4
    s_sub_u32 s93, s93, 1
    s_cmp_eq_u32 s93, 0
    s_cbranch_scc1 Lpuro4
    v_and_b32 v55, 15, v1
    v_lshlrev_b32 v55, 2, v55
    buffer_load_dword v63, v55, s[40:43], s58 offen sc1
    s_waitcnt vmcnt(0)
    s_branch Lpur2
Lpuro4:
    s_or_b32 s59, s59, s55
    v_cmp_ne_u32 vcc, s59, v63
    s_nop 1
    s_cmp_eq_u64 vcc, 0
    s_cselect_b32 s54, 1, 0
    s_lshl_b32 s59, s50, 2
    s_lshl_b32 s60, s91, 1
    s_add_u32 s59, s59, s60
    s_lshl_b32 s58, s49, 1
    s_add_u32 s58, s58, s90
    s_mul_i32 s58, s58, 32
    s_add_u32 s58, s58, s59
    s_lshl_b32 s58, s58, 10
    s_add_u32 s71, s58, 1048576
    s_cmp_eq_u32 s54, 0
    s_cbranch_scc1 Lst5
    buffer_store_dwordx4 v[144:147], v4, s[40:43], s71 offen offset:0
    buffer_store_dwordx4 v[148:151], v4, s[40:43], s71 offen offset:1024
    s_nop 1
    s_branch Lst6
Lst5:
    buffer_store_dwordx4 v[144:147], v4, s[40:43], s71 offen offset:0 sc1
    buffer_store_dwordx4 v[148:151], v4, s[40:43], s71 offen offset:1024 sc1
    s_nop 1
Lst6:
    s_lshl_b32 s64, s49, 1
    s_add_u32 s64, s64, s90
    s_mul_i32 s64, s64, 32
    s_lshl_b32 s61, s50, 2
    s_add_u32 s64, s64, s61
    s_lshl_b32 s61, s91, 1
    s_add_u32 s64, s64, s61
    s_lshl_b32 s64, s64, 10
    s_add_u32 s64, s64, 3145728
    s_mov_b64 exec, 0xffff
    buffer_load_dword v27, v5, s[40:43], s64 offen
    s_mov_b64 exec, -1
    s_lshl_b32 s64, s50, 1
    s_add_u32 s64, s64, s91
    s_lshl_b32 s64, s64, 11
    s_lshl_b32 s61, s49, 6
    s_add_u32 s64, s64, s61
    s_lshl_b32 s61, s90, 5
    s_add_u32 s64, s64, s61
    s_lshl_b32 s64, s64, 3
    s_add_u32 s64, s64, 7340032
    s_mov_b64 exec, 0x3
    buffer_load_dword v27, v5, s[40:43], s64 offen
    s_mov_b64 exec, -1
    s_lshl_b32 s64, s48, 13
    s_add_u32 m0, s64, 32768
    s_mul_i32 s64, s48, 114688
    s_lshl_b32 s61, s52, 8
    s_add_u32 s64, s64, s61
    s_add_u32 s64, s64, 458752
    buffer_load_dwordx4 v14, s[28:31], s64 offen lds
    buffer_load_dwordx4 v15, s[28:31], s64 offen offset:1024 lds
    buffer_load_dwordx4 v16, s[28:31], s64 offen offset:2048 lds
    buffer_load_dwordx4 v17, s[28:31], s64 offen offset:3072 lds
    s_waitcnt vmcnt(15)
    s_barrier
    s_cmp_eq_u32 s91, 0
    s_cselect_b64 vcc, -1, 0
    v_cndmask_b32 v38, v9, v8, vcc
    v_cndmask_b32 v39, v8, v9, vcc
    s_lshl_b32 s58, s91, 15
    s_add_u32 s58, s58, 86016
    v_add_u32 v38, s58, v38
    v_add_u32 v39, s58, v39
    v_pk_mul_f32 v[112:113], v[80:81], s[72:73]
    ds_read_b64_tr_b16 a[0:1], v38 offset:0
    v_pk_mul_f32 v[114:115], v[82:83], s[72:73]
    ds_read_b64_tr_b16 a[2:3], v38 offset:1024
    v_pk_mul_f32 v[116:117], v[84:85], s[72:73]
    ds_read_b64_tr_b16 a[4:5], v39 offset:0
    v_pk_mul_f32 v[118:119], v[86:87], s[72:73]
    ds_read_b64_tr_b16 a[6:7], v39 offset:1024
    v_pk_mul_f32 v[120:121], v[88:89], s[72:73]
    v_pk_mul_f32 v[122:123], v[90:91], s[72:73]
    ds_read_b64_tr_b16 a[8:9], v38 offset:2048
    v_pk_mul_f32 v[124:125], v[92:93], s[72:73]
    ds_read_b64_tr_b16 a[10:11], v38 offset:3072
    v_pk_mul_f32 v[126:127], v[94:95], s[72:73]
    ds_read_b64_tr_b16 a[12:13], v39 offset:2048
    v_min_f32 v112, 0, v112
    ds_read_b64_tr_b16 a[14:15], v39 offset:3072
    v_min_f32 v113, 0, v113
    v_min_f32 v114, 0, v114
    ds_read_b64_tr_b16 a[16:17], v38 offset:4096
    v_min_f32 v115, 0, v115
    ds_read_b64_tr_b16 a[18:19], v38 offset:5120
    v_min_f32 v116, 0, v116
    ds_read_b64_tr_b16 a[20:21], v39 offset:4096
    v_min_f32 v117, 0, v117
    ds_read_b64_tr_b16 a[22:23], v39 offset:5120
    v_min_f32 v118, 0, v118
    v_min_f32 v119, 0, v119
    ds_read_b64_tr_b16 a[24:25], v38 offset:6144
    v_min_f32 v120, 0, v120
    ds_read_b64_tr_b16 a[26:27], v38 offset:7168
    v_min_f32 v121, 0, v121
    ds_read_b64_tr_b16 a[28:29], v39 offset:6144
    v_min_f32 v122, 0, v122
    ds_read_b64_tr_b16 a[30:31], v39 offset:7168
    v_min_f32 v123, 0, v123
    v_min_f32 v124, 0, v124
    ds_read_b64_tr_b16 a[32:33], v38 offset:8192
    v_min_f32 v125, 0, v125
    ds_read_b64_tr_b16 a[34:35], v38 offset:9216
    v_min_f32 v126, 0, v126
    ds_read_b64_tr_b16 a[36:37], v39 offset:8192
    v_min_f32 v127, 0, v127
    ds_read_b64_tr_b16 a[38:39], v39 offset:9216
    v_exp_f32 v112, v112
    v_exp_f32 v113, v113
    ds_read_b64_tr_b16 a[40:41], v38 offset:10240
    v_exp_f32 v114, v114
    ds_read_b64_tr_b16 a[42:43], v38 offset:11264
    v_exp_f32 v115, v115
    ds_read_b64_tr_b16 a[44:45], v39 offset:10240
    v_exp_f32 v116, v116
    ds_read_b64_tr_b16 a[46:47], v39 offset:11264
    v_exp_f32 v117, v117
    v_exp_f32 v118, v118
    ds_read_b64_tr_b16 a[48:49], v38 offset:12288
    v_exp_f32 v119, v119
    ds_read_b64_tr_b16 a[50:51], v38 offset:13312
    v_exp_f32 v120, v120
    ds_read_b64_tr_b16 a[52:53], v39 offset:12288
    v_exp_f32 v121, v121
    ds_read_b64_tr_b16 a[54:55], v39 offset:13312
    v_exp_f32 v122, v122
    v_exp_f32 v123, v123
    ds_read_b64_tr_b16 a[56:57], v38 offset:14336
    v_exp_f32 v124, v124
    ds_read_b64_tr_b16 a[58:59], v38 offset:15360
    v_exp_f32 v125, v125
    ds_read_b64_tr_b16 a[60:61], v39 offset:14336
    v_exp_f32 v126, v126
    ds_read_b64_tr_b16 a[62:63], v39 offset:15360
    v_exp_f32 v127, v127
    v_max_f32 v80, 0, v80
    ds_read_b64_tr_b16 a[64:65], v38 offset:16384
    v_max_f32 v81, 0, v81
    ds_read_b64_tr_b16 a[66:67], v38 offset:17408
    v_max_f32 v82, 0, v82
    ds_read_b64_tr_b16 a[68:69], v39 offset:16384
    v_max_f32 v83, 0, v83
    ds_read_b64_tr_b16 a[70:71], v39 offset:17408
    v_max_f32 v84, 0, v84
    v_max_f32 v85, 0, v85
    ds_read_b64_tr_b16 a[72:73], v38 offset:18432
    v_max_f32 v86, 0, v86
    ds_read_b64_tr_b16 a[74:75], v38 offset:19456
    v_max_f32 v87, 0, v87
    ds_read_b64_tr_b16 a[76:77], v39 offset:18432
    v_max_f32 v88, 0, v88
    ds_read_b64_tr_b16 a[78:79], v39 offset:19456
    v_max_f32 v89, 0, v89
    v_max_f32 v90, 0, v90
    ds_read_b64_tr_b16 a[80:81], v38 offset:20480
    v_max_f32 v91, 0, v91
    ds_read_b64_tr_b16 a[82:83], v38 offset:21504
    v_max_f32 v92, 0, v92
    ds_read_b64_tr_b16 a[84:85], v39 offset:20480
    v_max_f32 v93, 0, v93
    ds_read_b64_tr_b16 a[86:87], v39 offset:21504
    v_max_f32 v94, 0, v94
    v_max_f32 v95, 0, v95
    ds_read_b64_tr_b16 a[88:89], v38 offset:22528
    v_pk_add_f32 v[80:81], v[80:81], v[112:113]
    ds_read_b64_tr_b16 a[90:91], v38 offset:23552
    v_pk_add_f32 v[82:83], v[82:83], v[114:115]
    ds_read_b64_tr_b16 a[92:93], v39 offset:22528
    v_pk_add_f32 v[84:85], v[84:85], v[116:117]
    ds_read_b64_tr_b16 a[94:95], v39 offset:23552
    v_pk_add_f32 v[86:87], v[86:87], v[118:119]
    v_pk_add_f32 v[88:89], v[88:89], v[120:121]
    ds_read_b64_tr_b16 a[96:97], v38 offset:24576
    v_pk_add_f32 v[90:91], v[90:91], v[122:123]
    ds_read_b64_tr_b16 a[98:99], v38 offset:25600
    v_pk_add_f32 v[92:93], v[92:93], v[124:125]
    ds_read_b64_tr_b16 a[100:101], v39 offset:24576
    v_pk_add_f32 v[94:95], v[94:95], v[126:127]
    ds_read_b64_tr_b16 a[102:103], v39 offset:25600
    v_pk_add_f32 v[80:81], v[80:81], s[76:77]
    v_pk_add_f32 v[82:83], v[82:83], s[76:77]
    ds_read_b64_tr_b16 a[104:105], v38 offset:26624
    v_pk_add_f32 v[84:85], v[84:85], s[76:77]
    ds_read_b64_tr_b16 a[106:107], v38 offset:27648
    v_pk_add_f32 v[86:87], v[86:87], s[76:77]
    ds_read_b64_tr_b16 a[108:109], v39 offset:26624
    v_pk_add_f32 v[88:89], v[88:89], s[76:77]
    ds_read_b64_tr_b16 a[110:111], v39 offset:27648
    v_pk_add_f32 v[90:91], v[90:91], s[76:77]
    v_pk_add_f32 v[92:93], v[92:93], s[76:77]
    ds_read_b64_tr_b16 a[112:113], v38 offset:28672
    v_pk_add_f32 v[94:95], v[94:95], s[76:77]
    ds_read_b64_tr_b16 a[114:115], v38 offset:29696
    v_cvt_pk_bf16_f32 v128, v80, v81
    ds_read_b64_tr_b16 a[116:117], v39 offset:28672
    v_cvt_pk_bf16_f32 v129, v82, v83
    ds_read_b64_tr_b16 a[118:119], v39 offset:29696
    v_cvt_pk_bf16_f32 v130, v84, v85
    v_cvt_pk_bf16_f32 v131, v86, v87
    ds_read_b64_tr_b16 a[120:121], v38 offset:30720
    v_cvt_pk_bf16_f32 v132, v88, v89
    ds_read_b64_tr_b16 a[122:123], v38 offset:31744
    v_cvt_pk_bf16_f32 v133, v90, v91
    ds_read_b64_tr_b16 a[124:125], v39 offset:30720
    v_cvt_pk_bf16_f32 v134, v92, v93
    ds_read_b64_tr_b16 a[126:127], v39 offset:31744
    v_cvt_pk_bf16_f32 v135, v94, v95
    s_lshl_b32 s64, s48, 13
    s_add_u32 m0, s64, 36864
    s_mul_i32 s64, s48, 114688
    s_lshl_b32 s61, s52, 8
    s_add_u32 s64, s64, s61
    s_add_u32 s64, s64, 458880
    buffer_load_dwordx4 v14, s[28:31], s64 offen lds
    buffer_load_dwordx4 v15, s[28:31], s64 offen offset:1024 lds
    buffer_load_dwordx4 v16, s[28:31], s64 offen offset:2048 lds
    buffer_load_dwordx4 v17, s[28:31], s64 offen offset:3072 lds
    v_cvt_pk_bf16_f32 v136, v96, v97
    v_cvt_pk_bf16_f32 v137, v98, v99
    v_cvt_pk_bf16_f32 v138, v100, v101
    v_cvt_pk_bf16_f32 v139, v102, v103
    v_cvt_pk_bf16_f32 v140, v104, v105
    v_cvt_pk_bf16_f32 v141, v106, v107
    v_cvt_pk_bf16_f32 v142, v108, v109
    v_cvt_pk_bf16_f32 v143, v110, v111
    v_mov_b32 v152, s78
    v_mov_b32 v153, s78
    v_mov_b32 v154, s78
    v_mov_b32 v155, s78
    v_mfma_f32_32x32x16_bf16 v[80:95], v[128:131], v[136:139], 0
    s_nop 0
    v_mfma_f32_32x32x16_bf16 v[96:111], v[128:131], v[152:155], 0
    v_mfma_f32_32x32x16_bf16 v[80:95], v[132:135], v[140:143], v[80:95]
    v_mfma_f32_32x32x16_bf16 v[96:111], v[132:135], v[152:155], v[96:111]
    s_waitcnt lgkmcnt(0)
    s_waitcnt vmcnt(10)
    s_barrier
    s_cmp_lg_u32 s48, 0
    s_nop 7
    s_cbranch_scc1 Lpub7
    s_lshl_b32 s58, s51, 7
    s_lshl_b32 s59, s52, 2
    s_add_u32 s58, s58, s59
    s_add_u32 s58, s58, 8192
    s_cmp_eq_u32 s54, 0
    s_cbranch_scc1 Lpub8
    v_mov_b32 v54, s53
    v_mov_b32 v55, 0
    v_cmp_eq_u32 vcc, 0, v1
    s_nop 1
    s_and_saveexec_b64 s[62:63], vcc
    buffer_store_dword v54, v55, s[40:43], s58 offen
    s_mov_b64 exec, s[62:63]
    s_branch Lpub9
Lpub8:
    v_mov_b32 v54, s53
    v_mov_b32 v55, 0
    v_cmp_eq_u32 vcc, 0, v1
    s_nop 1
    s_and_saveexec_b64 s[62:63], vcc
    buffer_store_dword v54, v55, s[40:43], s58 offen sc1
    s_mov_b64 exec, s[62:63]
Lpub9:
Lpub7:
    s_lshl_b32 s64, s48, 13
    s_add_u32 m0, s64, 69632
    s_mul_i32 s64, s48, 114688
    s_lshl_b32 s61, s52, 8
    s_add_u32 s64, s64, s61
    s_add_u32 s64, s64, 917504
    buffer_load_dwordx4 v14, s[28:31], s64 offen lds
    buffer_load_dwordx4 v15, s[28:31], s64 offen offset:1024 lds
    buffer_load_dwordx4 v16, s[28:31], s64 offen offset:2048 lds
    buffer_load_dwordx4 v17, s[28:31], s64 offen offset:3072 lds
    v_pk_mul_f32 v[112:113], v[64:65], s[72:73]
    s_lshl_b32 s64, s48, 13
    s_add_u32 m0, s64, 73728
    s_mul_i32 s64, s48, 114688
    s_lshl_b32 s61, s52, 8
    s_add_u32 s64, s64, s61
    s_add_u32 s64, s64, 917632
    buffer_load_dwordx4 v14, s[28:31], s64 offen lds
    v_pk_mul_f32 v[114:115], v[66:67], s[72:73]
    v_pk_mul_f32 v[116:117], v[68:69], s[72:73]
    v_pk_mul_f32 v[118:119], v[70:71], s[72:73]
    v_pk_mul_f32 v[120:121], v[72:73], s[72:73]
    v_pk_mul_f32 v[122:123], v[74:75], s[72:73]
    v_pk_mul_f32 v[124:125], v[76:77], s[72:73]
    v_pk_mul_f32 v[126:127], v[78:79], s[72:73]
    v_min_f32 v112, 0, v112
    v_min_f32 v113, 0, v113
    v_min_f32 v114, 0, v114
    buffer_load_dwordx4 v15, s[28:31], s64 offen offset:1024 lds
    v_min_f32 v115, 0, v115
    v_min_f32 v116, 0, v116
    v_min_f32 v117, 0, v117
    v_min_f32 v118, 0, v118
    v_min_f32 v119, 0, v119
    v_min_f32 v120, 0, v120
    v_min_f32 v121, 0, v121
    v_min_f32 v122, 0, v122
    v_min_f32 v123, 0, v123
    v_min_f32 v124, 0, v124
    buffer_load_dwordx4 v16, s[28:31], s64 offen offset:2048 lds
    v_min_f32 v125, 0, v125
    v_min_f32 v126, 0, v126
    v_min_f32 v127, 0, v127
    v_exp_f32 v112, v112
    v_exp_f32 v113, v113
    v_exp_f32 v114, v114
    v_exp_f32 v115, v115
    v_exp_f32 v116, v116
    v_exp_f32 v117, v117
    v_exp_f32 v118, v118
    buffer_load_dwordx4 v17, s[28:31], s64 offen offset:3072 lds
    v_exp_f32 v119, v119
    v_exp_f32 v120, v120
    v_exp_f32 v121, v121
    v_exp_f32 v122, v122
    v_exp_f32 v123, v123
    v_exp_f32 v124, v124
    v_exp_f32 v125, v125
    v_exp_f32 v126, v126
    v_exp_f32 v127, v127
    v_max_f32 v64, 0, v64
    s_lshl_b32 s64, s48, 13
    s_add_u32 m0, s64, 102400
    s_mul_i32 s64, s48, 114688
    s_lshl_b32 s61, s52, 8
    s_add_u32 s64, s64, s61
    s_add_u32 s64, s64, 1376256
    buffer_load_dwordx4 v14, s[28:31], s64 offen lds
    v_max_f32 v65, 0, v65
    v_max_f32 v66, 0, v66
    v_max_f32 v67, 0, v67
    v_max_f32 v68, 0, v68
    v_max_f32 v69, 0, v69
    v_max_f32 v70, 0, v70
    v_max_f32 v71, 0, v71
    v_max_f32 v72, 0, v72
    v_max_f32 v73, 0, v73
    v_max_f32 v74, 0, v74
    buffer_load_dwordx4 v15, s[28:31], s64 offen offset:1024 lds
    v_max_f32 v75, 0, v75
    v_max_f32 v76, 0, v76
    v_max_f32 v77, 0, v77
    v_max_f32 v78, 0, v78
    v_max_f32 v79, 0, v79
    v_pk_add_f32 v[64:65], v[64:65], v[112:113]
    v_pk_add_f32 v[66:67], v[66:67], v[114:115]
    v_pk_add_f32 v[68:69], v[68:69], v[116:117]
    v_pk_add_f32 v[70:71], v[70:71], v[118:119]
    v_pk_add_f32 v[72:73], v[72:73], v[120:121]
    buffer_load_dwordx4 v16, s[28:31], s64 offen offset:2048 lds
    v_pk_add_f32 v[74:75], v[74:75], v[122:123]
    v_pk_add_f32 v[76:77], v[76:77], v[124:125]
    v_pk_add_f32 v[78:79], v[78:79], v[126:127]
    v_pk_add_f32 v[64:65], v[64:65], s[76:77]
    v_pk_add_f32 v[66:67], v[66:67], s[76:77]
    v_pk_add_f32 v[68:69], v[68:69], s[76:77]
    v_pk_add_f32 v[70:71], v[70:71], s[76:77]
    v_pk_add_f32 v[72:73], v[72:73], s[76:77]
    v_pk_add_f32 v[74:75], v[74:75], s[76:77]
    v_pk_add_f32 v[76:77], v[76:77], s[76:77]
    buffer_load_dwordx4 v17, s[28:31], s64 offen offset:3072 lds
    v_pk_add_f32 v[78:79], v[78:79], s[76:77]
    v_cvt_pk_bf16_f32 v240, v64, v65
    v_cvt_pk_bf16_f32 v241, v66, v67
    v_cvt_pk_bf16_f32 v242, v68, v69
    v_cvt_pk_bf16_f32 v243, v70, v71
    v_cvt_pk_bf16_f32 v244, v72, v73
    v_cvt_pk_bf16_f32 v245, v74, v75
    v_cvt_pk_bf16_f32 v246, v76, v77
    v_cvt_pk_bf16_f32 v247, v78, v79
    v_and_b32 v54, 16, v1
    v_cmp_ne_u32 vcc, 0, v54
    s_nop 1
    v_cndmask_b32 v80, v80, v96, vcc
    v_cndmask_b32 v81, v81, v97, vcc
    v_cndmask_b32 v82, v82, v98, vcc
    v_cndmask_b32 v83, v83, v99, vcc
    v_cndmask_b32 v84, v84, v100, vcc
    v_cndmask_b32 v85, v85, v101, vcc
    v_cndmask_b32 v86, v86, v102, vcc
    v_cndmask_b32 v87, v87, v103, vcc
    v_cndmask_b32 v88, v104, v88, vcc
    v_cndmask_b32 v89, v105, v89, vcc
    v_cndmask_b32 v90, v106, v90, vcc
    v_cndmask_b32 v91, v107, v91, vcc
    v_cndmask_b32 v92, v108, v92, vcc
    v_cndmask_b32 v93, v109, v93, vcc
    v_cndmask_b32 v94, v110, v94, vcc
    v_cndmask_b32 v95, v111, v95, vcc
    s_lshl_b32 s64, s48, 13
    s_add_u32 m0, s64, 106496
    s_mul_i32 s64, s48, 114688
    s_lshl_b32 s61, s52, 8
    s_add_u32 s64, s64, s61
    s_add_u32 s64, s64, 1376384
    buffer_load_dwordx4 v14, s[28:31], s64 offen lds
    buffer_load_dwordx4 v15, s[28:31], s64 offen offset:1024 lds
    buffer_load_dwordx4 v16, s[28:31], s64 offen offset:2048 lds
    buffer_load_dwordx4 v17, s[28:31], s64 offen offset:3072 lds
    s_lshl_b32 s58, s91, 12
    s_add_u32 s58, s58, 135168
    v_add_u32 v54, s58, v4
    s_lshl_b32 s58, s51, 7
    s_and_b32 s59, s49, 1
    s_lshl_b32 s59, s59, 5
    s_add_u32 s58, s58, s59
    s_add_u32 s58, s58, 8192
    s_mov_b32 s79, s58
    v_min_u32 v63, 7, v1
    v_lshlrev_b32 v63, 2, v63
    buffer_load_dword v63, v63, s[40:43], s79 offen sc1
    s_cmp_eq_u32 s90, 0
    s_cbranch_scc1 La110
    ds_write_b128 v54, v[80:83] offset:0
    ds_write_b128 v54, v[84:87] offset:1024
    ds_write_b128 v54, v[88:91] offset:2048
    ds_write_b128 v54, v[92:95] offset:3072
La110:
    s_waitcnt lgkmcnt(0)
    s_barrier
    s_cmp_lg_u32 s90, 0
    s_cbranch_scc1 La111
    ds_read_b128 v[96:99], v54 offset:0
    ds_read_b128 v[100:103], v54 offset:1024
    ds_read_b128 v[104:107], v54 offset:2048
    ds_read_b128 v[108:111], v54 offset:3072
    s_waitcnt lgkmcnt(0)
    v_pk_add_f32 v[80:81], v[80:81], v[96:97]
    v_pk_add_f32 v[82:83], v[82:83], v[98:99]
    v_pk_add_f32 v[84:85], v[84:85], v[100:101]
    v_pk_add_f32 v[86:87], v[86:87], v[102:103]
    v_pk_add_f32 v[88:89], v[88:89], v[104:105]
    v_pk_add_f32 v[90:91], v[90:91], v[106:107]
    v_pk_add_f32 v[92:93], v[92:93], v[108:109]
    v_pk_add_f32 v[94:95], v[94:95], v[110:111]
    s_nop 1
La111:
    s_waitcnt vmcnt(0)
    s_mov_b32 s93, 0x40000
Lfw12:
    v_cmp_ne_u32 vcc, s53, v63
    s_nop 4
    s_cbranch_vccz Lfwo13
    s_sub_u32 s93, s93, 1
    s_cmp_eq_u32 s93, 0
    s_cbranch_scc1 Lfwo13
    v_min_u32 v55, 7, v1
    v_lshlrev_b32 v55, 2, v55
    buffer_load_dword v63, v55, s[40:43], s79 offen sc1
    s_waitcnt vmcnt(0)
    s_branch Lfw12
Lfwo13:
    s_lshl_b32 s59, s91, 4
    s_lshl_b32 s58, s49, 1
    s_add_u32 s58, s58, s90
    s_mul_i32 s58, s58, 32
    s_add_u32 s58, s58, s59
    s_lshl_b32 s58, s58, 10
    s_add_u32 s71, s58, 1048576
    s_add_u32 s64, s71, 0
    buffer_load_dwordx4 v[128:131], v4, s[40:43], s64 offen offset:0 sc1
    buffer_load_dwordx4 v[132:135], v4, s[40:43], s64 offen offset:1024 sc1
    buffer_load_dwordx4 v[136:139], v4, s[40:43], s64 offen offset:2048 sc1
    buffer_load_dwordx4 v[140:143], v4, s[40:43], s64 offen offset:3072 sc1
    s_add_u32 s64, s71, 4096
    buffer_load_dwordx4 v[144:147], v4, s[40:43], s64 offen offset:0 sc1
    buffer_load_dwordx4 v[148:151], v4, s[40:43], s64 offen offset:1024 sc1
    buffer_load_dwordx4 v[152:155], v4, s[40:43], s64 offen offset:2048 sc1
    buffer_load_dwordx4 v[156:159], v4, s[40:43], s64 offen offset:3072 sc1
    s_waitcnt vmcnt(7)
    v_mfma_f32_32x32x16_bf16 v[96:111], a[0:3], v[128:131], 0
    s_add_u32 s64, s71, 8192
    buffer_load_dwordx4 v[160:163], v4, s[40:43], s64 offen offset:0 sc1
    v_mfma_f32_32x32x16_bf16 v[112:127], a[4:7], v[128:131], 0
    s_waitcnt vmcnt(7)
    v_mfma_f32_32x32x16_bf16 v[96:111], a[8:11], v[132:135], v[96:111]
    buffer_load_dwordx4 v[164:167], v4, s[40:43], s64 offen offset:1024 sc1
    v_mfma_f32_32x32x16_bf16 v[112:127], a[12:15], v[132:135], v[112:127]
    s_waitcnt vmcnt(7)
    v_mfma_f32_32x32x16_bf16 v[96:111], a[16:19], v[136:139], v[96:111]
    buffer_load_dwordx4 v[168:171], v4, s[40:43], s64 offen offset:2048 sc1
    v_mfma_f32_32x32x16_bf16 v[112:127], a[20:23], v[136:139], v[112:127]
    s_waitcnt vmcnt(7)
    v_mfma_f32_32x32x16_bf16 v[96:111], a[24:27], v[140:143], v[96:111]
    buffer_load_dwordx4 v[172:175], v4, s[40:43], s64 offen offset:3072 sc1
    v_mfma_f32_32x32x16_bf16 v[112:127], a[28:31], v[140:143], v[112:127]
    s_waitcnt vmcnt(7)
    v_mfma_f32_32x32x16_bf16 v[96:111], a[32:35], v[144:147], v[96:111]
    s_add_u32 s64, s71, 12288
    buffer_load_dwordx4 v[176:179], v4, s[40:43], s64 offen offset:0 sc1
    v_mfma_f32_32x32x16_bf16 v[112:127], a[36:39], v[144:147], v[112:127]
    s_waitcnt vmcnt(7)
    v_mfma_f32_32x32x16_bf16 v[96:111], a[40:43], v[148:151], v[96:111]
    buffer_load_dwordx4 v[180:183], v4, s[40:43], s64 offen offset:1024 sc1
    v_mfma_f32_32x32x16_bf16 v[112:127], a[44:47], v[148:151], v[112:127]
    s_waitcnt vmcnt(7)
    v_mfma_f32_32x32x16_bf16 v[96:111], a[48:51], v[152:155], v[96:111]
    buffer_load_dwordx4 v[184:187], v4, s[40:43], s64 offen offset:2048 sc1
    v_mfma_f32_32x32x16_bf16 v[112:127], a[52:55], v[152:155], v[112:127]
    s_waitcnt vmcnt(7)
    v_mfma_f32_32x32x16_bf16 v[96:111], a[56:59], v[156:159], v[96:111]
    buffer_load_dwordx4 v[188:191], v4, s[40:43], s64 offen offset:3072 sc1
    v_mfma_f32_32x32x16_bf16 v[112:127], a[60:63], v[156:159], v[112:127]
    s_waitcnt vmcnt(7)
    v_mfma_f32_32x32x16_bf16 v[96:111], a[64:67], v[160:163], v[96:111]
    v_mfma_f32_32x32x16_bf16 v[112:127], a[68:71], v[160:163], v[112:127]
    s_waitcnt vmcnt(6)
    v_mfma_f32_32x32x16_bf16 v[96:111], a[72:75], v[164:167], v[96:111]
    v_mfma_f32_32x32x16_bf16 v[112:127], a[76:79], v[164:167], v[112:127]
    s_waitcnt vmcnt(5)
    v_mfma_f32_32x32x16_bf16 v[96:111], a[80:83], v[168:171], v[96:111]
    v_mfma_f32_32x32x16_bf16 v[112:127], a[84:87], v[168:171], v[112:127]
    s_waitcnt vmcnt(4)
    v_mfma_f32_32x32x16_bf16 v[96:111], a[88:91], v[172:175], v[96:111]
    v_mfma_f32_32x32x16_bf16 v[112:127], a[92:95], v[172:175], v[112:127]
    s_waitcnt vmcnt(3)
    v_mfma_f32_32x32x16_bf16 v[96:111], a[96:99], v[176:179], v[96:111]
    v_mfma_f32_32x32x16_bf16 v[112:127], a[100:103], v[176:179], v[112:127]
    s_waitcnt vmcnt(2)
    v_mfma_f32_32x32x16_bf16 v[96:111], a[104:107], v[180:183], v[96:111]
    v_mfma_f32_32x32x16_bf16 v[112:127], a[108:111], v[180:183], v[112:127]
    s_waitcnt vmcnt(1)
    v_mfma_f32_32x32x16_bf16 v[96:111], a[112:115], v[184:187], v[96:111]
    v_mfma_f32_32x32x16_bf16 v[112:127], a[116:119], v[184:187], v[112:127]
    s_waitcnt vmcnt(0)
    v_mfma_f32_32x32x16_bf16 v[96:111], a[120:123], v[188:191], v[96:111]
    v_mfma_f32_32x32x16_bf16 v[112:127], a[124:127], v[188:191], v[112:127]
    s_lshl_b32 s59, s50, 2
    s_lshl_b32 s60, s91, 1
    s_add_u32 s59, s59, s60
    s_lshl_b32 s58, s49, 1
    s_add_u32 s58, s58, s90
    s_mul_i32 s58, s58, 32
    s_add_u32 s58, s58, s59
    s_lshl_b32 s58, s58, 10
    s_add_u32 s80, s58, 5242880
    buffer_store_dwordx4 v[240:243], v4, s[40:43], s80 offen offset:0 sc1
    buffer_store_dwordx4 v[244:247], v4, s[40:43], s80 offen offset:1024 sc1
    s_cmp_lg_u32 s90, 0
    s_nop 0
    s_cbranch_scc1 Lkv14
    v_and_b32 v55, 15, v2
    v_mov_b32 v56, 16
    v_and_b32 v57, 16, v1
    v_cmp_ne_u32 vcc, 0, v57
    s_nop 1
    v_cndmask_b32 v58, v55, v56, vcc
    v_cndmask_b32 v59, v56, v55, vcc
    v_mul_u32_u24 v57, 544, v3
    v_lshlrev_b32 v58, 5, v58
    v_add_u32 v58, v58, v57
    v_lshlrev_b32 v59, 5, v59
    v_add_u32 v59, v59, v57
    s_lshl_b32 s58, s49, 3
    s_add_u32 s58, s58, s50
    s_mul_i32 s58, s58, 4352
    s_mul_i32 s59, s91, 2176
    s_add_u32 s58, s58, s59
    s_add_u32 s80, s58, 8388608
    buffer_store_dwordx4 v[80:83], v58, s[40:43], s80 offen offset:0 sc1
    buffer_store_dwordx4 v[84:87], v58, s[40:43], s80 offen offset:16 sc1
    buffer_store_dwordx4 v[88:91], v59, s[40:43], s80 offen offset:1088 sc1
    buffer_store_dwordx4 v[92:95], v59, s[40:43], s80 offen offset:1104 sc1
    s_nop 1
Lkv14:
    s_lshl_b32 s58, s48, 12
    s_add_u32 s58, s58, 135168
    v_add_u32 v38, s58, v4
    s_xor_b32 s58, s48, 1
    s_lshl_b32 s58, s58, 12
    s_add_u32 s58, s58, 135168
    v_add_u32 v39, s58, v4
    ds_write_b128 v38, v[112:115] offset:0
    ds_write_b128 v38, v[116:119] offset:1024
    ds_write_b128 v38, v[120:123] offset:2048
    ds_write_b128 v38, v[124:127] offset:3072
    s_waitcnt lgkmcnt(0)
    s_barrier
    ds_read_b128 v[112:115], v39 offset:0
    ds_read_b128 v[116:119], v39 offset:1024
    ds_read_b128 v[120:123], v39 offset:2048
    ds_read_b128 v[124:127], v39 offset:3072
    s_waitcnt lgkmcnt(3)
    v_pk_add_f32 v[96:97], v[96:97], v[112:113]
    v_pk_add_f32 v[98:99], v[98:99], v[114:115]
    s_waitcnt lgkmcnt(2)
    v_pk_add_f32 v[100:101], v[100:101], v[116:117]
    v_pk_add_f32 v[102:103], v[102:103], v[118:119]
    s_waitcnt lgkmcnt(1)
    v_pk_add_f32 v[104:105], v[104:105], v[120:121]
    v_pk_add_f32 v[106:107], v[106:107], v[122:123]
    s_waitcnt lgkmcnt(0)
    v_pk_add_f32 v[108:109], v[108:109], v[124:125]
    v_pk_add_f32 v[110:111], v[110:111], v[126:127]
    s_lshl_b32 s64, s67, 2
    s_add_u32 s64, s64, s48
    s_lshl_b32 s64, s64, 11
    s_mov_b64 exec, 0xffff
    buffer_load_dword v27, v5, s[12:15], s64 offen
    s_mov_b64 exec, -1
    v_lshlrev_b32 v54, 16, v30
    v_and_b32 v55, 0xffff0000, v30
    v_pk_add_f32 v[96:97], v[96:97], v[54:55]
    v_cvt_pk_bf16_f32 v30, v96, v97
    v_lshlrev_b32 v54, 16, v31
    v_and_b32 v55, 0xffff0000, v31
    v_pk_add_f32 v[98:99], v[98:99], v[54:55]
    v_cvt_pk_bf16_f32 v31, v98, v99
    v_lshlrev_b32 v54, 16, v32
    v_and_b32 v55, 0xffff0000, v32
    v_pk_add_f32 v[100:101], v[100:101], v[54:55]
    v_cvt_pk_bf16_f32 v32, v100, v101
    v_lshlrev_b32 v54, 16, v33
    v_and_b32 v55, 0xffff0000, v33
    v_pk_add_f32 v[102:103], v[102:103], v[54:55]
    v_cvt_pk_bf16_f32 v33, v102, v103
    v_lshlrev_b32 v54, 16, v34
    v_and_b32 v55, 0xffff0000, v34
    v_pk_add_f32 v[104:105], v[104:105], v[54:55]
    v_cvt_pk_bf16_f32 v34, v104, v105
    v_lshlrev_b32 v54, 16, v35
    v_and_b32 v55, 0xffff0000, v35
    v_pk_add_f32 v[106:107], v[106:107], v[54:55]
    v_cvt_pk_bf16_f32 v35, v106, v107
    v_lshlrev_b32 v54, 16, v36
    v_and_b32 v55, 0xffff0000, v36
    v_pk_add_f32 v[108:109], v[108:109], v[54:55]
    v_cvt_pk_bf16_f32 v36, v108, v109
    v_lshlrev_b32 v54, 16, v37
    v_and_b32 v55, 0xffff0000, v37
    v_pk_add_f32 v[110:111], v[110:111], v[54:55]
    v_cvt_pk_bf16_f32 v37, v110, v111
    s_lshl_b32 s59, s50, 2
    s_lshl_b32 s60, s91, 1
    s_add_u32 s59, s59, s60
    s_lshl_b32 s58, s49, 1
    s_add_u32 s58, s58, s90
    s_mul_i32 s58, s58, 32
    s_add_u32 s58, s58, s59
    s_lshl_b32 s58, s58, 10
    s_add_u32 s71, s58, 3145728
    v_mov_b32 v128, 0
    v_mov_b32 v129, 0
    v_mov_b32 v130, 0
    v_mov_b32 v131, 0
    v_dot2c_f32_bf16 v128, s78, v30
    v_dot2c_f32_bf16 v130, v30, v30
    v_dot2c_f32_bf16 v129, s78, v31
    v_dot2c_f32_bf16 v131, v31, v31
    v_dot2c_f32_bf16 v128, s78, v32
    v_dot2c_f32_bf16 v130, v32, v32
    v_dot2c_f32_bf16 v129, s78, v33
    v_dot2c_f32_bf16 v131, v33, v33
    v_dot2c_f32_bf16 v128, s78, v34
    v_dot2c_f32_bf16 v130, v34, v34
    v_dot2c_f32_bf16 v129, s78, v35
    v_dot2c_f32_bf16 v131, v35, v35
    v_dot2c_f32_bf16 v128, s78, v36
    v_dot2c_f32_bf16 v130, v36, v36
    v_dot2c_f32_bf16 v129, s78, v37
    v_dot2c_f32_bf16 v131, v37, v37
    s_nop 1
    v_add_f32 v128, v128, v129
    v_add_f32 v129, v130, v131
    v_mov_b32 v54, v128
    s_nop 1
    v_permlane32_swap_b32 v128, v54
    v_add_f32 v128, v128, v54
    v_mov_b32 v54, v129
    s_nop 1
    v_permlane32_swap_b32 v129, v54
    v_add_f32 v129, v129, v54
    s_lshl_b32 s58, s50, 1
    s_add_u32 s58, s58, s91
    s_lshl_b32 s58, s58, 11
    s_lshl_b32 s59, s49, 6
    s_add_u32 s58, s58, s59
    s_lshl_b32 s59, s90, 5
    s_add_u32 s58, s58, s59
    s_lshl_b32 s58, s58, 3
    s_add_u32 s80, s58, 7340032
    v_lshlrev_b32 v56, 3, v2
    s_cmp_eq_u32 s54, 0
    s_nop 0
    s_cbranch_scc1 Lst15
    buffer_store_dwordx4 v[30:33], v4, s[40:43], s71 offen offset:0
    buffer_store_dwordx4 v[34:37], v4, s[40:43], s71 offen offset:1024
    buffer_store_dwordx2 v[128:129], v56, s[40:43], s80 offen
    s_nop 0
    s_branch Lst16
Lst15:
    buffer_store_dwordx4 v[30:33], v4, s[40:43], s71 offen offset:0 sc1
    buffer_store_dwordx4 v[34:37], v4, s[40:43], s71 offen offset:1024 sc1
    buffer_store_dwordx2 v[128:129], v56, s[40:43], s80 offen sc1
    s_nop 0
Lst16:
    s_cmp_ge_u32 s52, 14
    s_cbranch_scc1 Lcs17
    s_cmp_eq_u32 s91, 0
    s_cselect_b64 vcc, -1, 0
    v_cndmask_b32 v42, v9, v8, vcc
    s_lshl_b32 s58, s90, 12
    v_add_u32 v42, s58, v42
    v_add_u32 v43, 69632, v42
    v_mov_b32 v132, 0
    v_mov_b32 v133, 0
    v_mov_b32 v134, 0
    v_mov_b32 v135, 0
    ds_read_b64_tr_b16 v[136:137], v42 offset:0
    ds_read_b64_tr_b16 v[138:139], v42 offset:1024
    ds_read_b64_tr_b16 v[140:141], v42 offset:2048
    ds_read_b64_tr_b16 v[142:143], v42 offset:3072
    ds_read_b64_tr_b16 v[144:145], v42 offset:8192
    ds_read_b64_tr_b16 v[146:147], v42 offset:9216
    ds_read_b64_tr_b16 v[148:149], v42 offset:10240
    ds_read_b64_tr_b16 v[150:151], v42 offset:11264
    ds_read_b64_tr_b16 v[152:153], v42 offset:16384
    ds_read_b64_tr_b16 v[154:155], v42 offset:17408
    ds_read_b64_tr_b16 v[156:157], v42 offset:18432
    ds_read_b64_tr_b16 v[158:159], v42 offset:19456
    s_waitcnt lgkmcnt(10)
    v_dot2c_f32_bf16 v132, s78, v136
    v_dot2c_f32_bf16 v133, s78, v137
    v_dot2c_f32_bf16 v134, s78, v138
    v_dot2c_f32_bf16 v135, s78, v139
    ds_read_b64_tr_b16 v[136:137], v42 offset:24576
    ds_read_b64_tr_b16 v[138:139], v42 offset:25600
    s_waitcnt lgkmcnt(10)
    v_dot2c_f32_bf16 v132, s78, v140
    v_dot2c_f32_bf16 v133, s78, v141
    v_dot2c_f32_bf16 v134, s78, v142
    v_dot2c_f32_bf16 v135, s78, v143
    ds_read_b64_tr_b16 v[140:141], v42 offset:26624
    ds_read_b64_tr_b16 v[142:143], v42 offset:27648
    s_waitcnt lgkmcnt(10)
    v_dot2c_f32_bf16 v132, s78, v144
    v_dot2c_f32_bf16 v133, s78, v145
    v_dot2c_f32_bf16 v134, s78, v146
    v_dot2c_f32_bf16 v135, s78, v147
    ds_read_b64_tr_b16 v[144:145], v42 offset:32768
    ds_read_b64_tr_b16 v[146:147], v42 offset:33792
    s_waitcnt lgkmcnt(10)
    v_dot2c_f32_bf16 v132, s78, v148
    v_dot2c_f32_bf16 v133, s78, v149
    v_dot2c_f32_bf16 v134, s78, v150
    v_dot2c_f32_bf16 v135, s78, v151
    ds_read_b64_tr_b16 v[148:149], v42 offset:34816
    ds_read_b64_tr_b16 v[150:151], v42 offset:35840
    s_waitcnt lgkmcnt(10)
    v_dot2c_f32_bf16 v132, s78, v152
    v_dot2c_f32_bf16 v133, s78, v153
    v_dot2c_f32_bf16 v134, s78, v154
    v_dot2c_f32_bf16 v135, s78, v155
    ds_read_b64_tr_b16 v[152:153], v42 offset:40960
    ds_read_b64_tr_b16 v[154:155], v42 offset:41984
    s_waitcnt lgkmcnt(10)
    v_dot2c_f32_bf16 v132, s78, v156
    v_dot2c_f32_bf16 v133, s78, v157
    v_dot2c_f32_bf16 v134, s78, v158
    v_dot2c_f32_bf16 v135, s78, v159
    ds_read_b64_tr_b16 v[156:157], v42 offset:43008
    ds_read_b64_tr_b16 v[158:159], v42 offset:44032
    s_waitcnt lgkmcnt(10)
    v_dot2c_f32_bf16 v132, s78, v136
    v_dot2c_f32_bf16 v133, s78, v137
    v_dot2c_f32_bf16 v134, s78, v138
    v_dot2c_f32_bf16 v135, s78, v139
    ds_read_b64_tr_b16 v[136:137], v42 offset:49152
    ds_read_b64_tr_b16 v[138:139], v42 offset:50176
    s_waitcnt lgkmcnt(10)
    v_dot2c_f32_bf16 v132, s78, v140
    v_dot2c_f32_bf16 v133, s78, v141
    v_dot2c_f32_bf16 v134, s78, v142
    v_dot2c_f32_bf16 v135, s78, v143
    ds_read_b64_tr_b16 v[140:141], v42 offset:51200
    ds_read_b64_tr_b16 v[142:143], v42 offset:52224
    s_waitcnt lgkmcnt(10)
    v_dot2c_f32_bf16 v132, s78, v144
    v_dot2c_f32_bf16 v133, s78, v145
    v_dot2c_f32_bf16 v134, s78, v146
    v_dot2c_f32_bf16 v135, s78, v147
    ds_read_b64_tr_b16 v[144:145], v42 offset:57344
    ds_read_b64_tr_b16 v[146:147], v42 offset:58368
    s_waitcnt lgkmcnt(10)
    v_dot2c_f32_bf16 v132, s78, v148
    v_dot2c_f32_bf16 v133, s78, v149
    v_dot2c_f32_bf16 v134, s78, v150
    v_dot2c_f32_bf16 v135, s78, v151
    ds_read_b64_tr_b16 v[148:149], v42 offset:59392
    ds_read_b64_tr_b16 v[150:151], v42 offset:60416
    s_waitcnt lgkmcnt(10)
    v_dot2c_f32_bf16 v132, s78, v152
    v_dot2c_f32_bf16 v133, s78, v153
    v_dot2c_f32_bf16 v134, s78, v154
    v_dot2c_f32_bf16 v135, s78, v155
    s_waitcnt lgkmcnt(8)
    v_dot2c_f32_bf16 v132, s78, v156
    v_dot2c_f32_bf16 v133, s78, v157
    v_dot2c_f32_bf16 v134, s78, v158
    v_dot2c_f32_bf16 v135, s78, v159
    s_waitcnt lgkmcnt(6)
    v_dot2c_f32_bf16 v132, s78, v136
    v_dot2c_f32_bf16 v133, s78, v137
    v_dot2c_f32_bf16 v134, s78, v138
    v_dot2c_f32_bf16 v135, s78, v139
    s_waitcnt lgkmcnt(4)
    v_dot2c_f32_bf16 v132, s78, v140
    v_dot2c_f32_bf16 v133, s78, v141
    v_dot2c_f32_bf16 v134, s78, v142
    v_dot2c_f32_bf16 v135, s78, v143
    s_waitcnt lgkmcnt(2)
    v_dot2c_f32_bf16 v132, s78, v144
    v_dot2c_f32_bf16 v133, s78, v145
    v_dot2c_f32_bf16 v134, s78, v146
    v_dot2c_f32_bf16 v135, s78, v147
    s_waitcnt lgkmcnt(0)
    v_dot2c_f32_bf16 v132, s78, v148
    v_dot2c_f32_bf16 v133, s78, v149
    v_dot2c_f32_bf16 v134, s78, v150
    v_dot2c_f32_bf16 v135, s78, v151
    s_nop 2
Lcs17:
    s_waitcnt vmcnt(0)
    s_barrier
    s_cmp_lg_u32 s48, 0
    s_cbranch_scc1 Lpub18
    s_lshl_b32 s58, s51, 7
    s_lshl_b32 s59, s52, 2
    s_add_u32 s58, s58, s59
    s_add_u32 s58, s58, 12288
    s_cmp_eq_u32 s54, 0
    s_cbranch_scc1 Lpub19
    v_mov_b32 v54, s53
    v_mov_b32 v55, 0
    v_cmp_eq_u32 vcc, 0, v1
    s_nop 1
    s_and_saveexec_b64 s[62:63], vcc
    buffer_store_dword v54, v55, s[40:43], s58 offen
    s_mov_b64 exec, s[62:63]
    s_branch Lpub20
Lpub19:
    v_mov_b32 v54, s53
    v_mov_b32 v55, 0
    v_cmp_eq_u32 vcc, 0, v1
    s_nop 1
    s_and_saveexec_b64 s[62:63], vcc
    buffer_store_dword v54, v55, s[40:43], s58 offen sc1
    s_mov_b64 exec, s[62:63]
Lpub20:
Lpub18:
    s_cmp_lg_u32 s48, 0
    s_cbranch_scc1 Lfa121
    s_lshl_b32 s58, s50, 7
    s_lshl_b32 s59, s49, 2
    s_add_u32 s58, s58, s59
    s_add_u32 s58, s58, 20480
    v_mov_b32 v54, s53
    v_mov_b32 v55, 0
    v_cmp_eq_u32 vcc, 0, v1
    s_nop 1
    s_and_saveexec_b64 s[62:63], vcc
    buffer_store_dword v54, v55, s[40:43], s58 offen sc1
    s_mov_b64 exec, s[62:63]
Lfa121:
    s_lshl_b32 s64, s67, 2
    s_add_u32 s64, s64, s48
    s_lshl_b32 s64, s64, 11
    s_add_u32 s64, s64, 262144
    s_mov_b64 exec, 0xffff
    buffer_load_dword v27, v5, s[12:15], s64 offen
    s_mov_b64 exec, -1
    s_lshl_b32 s64, s67, 2
    s_add_u32 s64, s64, s48
    s_lshl_b32 s64, s64, 11
    s_mov_b64 exec, 0xffff
    buffer_load_dword v27, v5, s[32:35], s64 offen
    s_mov_b64 exec, -1
    s_cmp_ge_u32 s52, 14
    s_cbranch_scc1 LA222
L_b3start:
    s_lshl_b32 s58, s51, 7
    s_add_u32 s58, s58, 12288
    s_mov_b32 s79, s58
    v_min_u32 v63, 15, v1
    v_lshlrev_b32 v63, 2, v63
    buffer_load_dword v63, v63, s[40:43], s79 offen sc1
    ds_read_b64_tr_b16 v[152:153], v43 offset:0
    ds_read_b64_tr_b16 v[154:155], v43 offset:1024
    ds_read_b64_tr_b16 v[156:157], v43 offset:2048
    ds_read_b64_tr_b16 v[158:159], v43 offset:3072
    ds_read_b64_tr_b16 v[136:137], v43 offset:8192
    ds_read_b64_tr_b16 v[138:139], v43 offset:9216
    ds_read_b64_tr_b16 v[140:141], v43 offset:10240
    ds_read_b64_tr_b16 v[142:143], v43 offset:11264
    ds_read_b64_tr_b16 v[144:145], v43 offset:16384
    ds_read_b64_tr_b16 v[146:147], v43 offset:17408
    ds_read_b64_tr_b16 v[148:149], v43 offset:18432
    ds_read_b64_tr_b16 v[150:151], v43 offset:19456
    s_waitcnt lgkmcnt(10)
    v_dot2c_f32_bf16 v132, s78, v152
    v_dot2c_f32_bf16 v133, s78, v153
    v_dot2c_f32_bf16 v134, s78, v154
    v_dot2c_f32_bf16 v135, s78, v155
    ds_read_b64_tr_b16 v[152:153], v43 offset:24576
    ds_read_b64_tr_b16 v[154:155], v43 offset:25600
    s_waitcnt lgkmcnt(10)
    v_dot2c_f32_bf16 v132, s78, v156
    v_dot2c_f32_bf16 v133, s78, v157
    v_dot2c_f32_bf16 v134, s78, v158
    v_dot2c_f32_bf16 v135, s78, v159
    ds_read_b64_tr_b16 v[156:157], v43 offset:26624
    ds_read_b64_tr_b16 v[158:159], v43 offset:27648
    s_waitcnt lgkmcnt(10)
    v_dot2c_f32_bf16 v132, s78, v136
    v_dot2c_f32_bf16 v133, s78, v137
    v_dot2c_f32_bf16 v134, s78, v138
    v_dot2c_f32_bf16 v135, s78, v139
    ds_read_b64_tr_b16 v[136:137], v43 offset:32768
    ds_read_b64_tr_b16 v[138:139], v43 offset:33792
    s_waitcnt lgkmcnt(10)
    v_dot2c_f32_bf16 v132, s78, v140
    v_dot2c_f32_bf16 v133, s78, v141
    v_dot2c_f32_bf16 v134, s78, v142
    v_dot2c_f32_bf16 v135, s78, v143
    ds_read_b64_tr_b16 v[140:141], v43 offset:34816
    ds_read_b64_tr_b16 v[142:143], v43 offset:35840
    s_waitcnt lgkmcnt(10)
    v_dot2c_f32_bf16 v132, s78, v144
    v_dot2c_f32_bf16 v133, s78, v145
    v_dot2c_f32_bf16 v134, s78, v146
    v_dot2c_f32_bf16 v135, s78, v147
    ds_read_b64_tr_b16 v[144:145], v43 offset:40960
    ds_read_b64_tr_b16 v[146:147], v43 offset:41984
    s_waitcnt lgkmcnt(10)
    v_dot2c_f32_bf16 v132, s78, v148
    v_dot2c_f32_bf16 v133, s78, v149
    v_dot2c_f32_bf16 v134, s78, v150
    v_dot2c_f32_bf16 v135, s78, v151
    ds_read_b64_tr_b16 v[148:149], v43 offset:43008
    ds_read_b64_tr_b16 v[150:151], v43 offset:44032
    s_waitcnt lgkmcnt(10)
    v_dot2c_f32_bf16 v132, s78, v152
    v_dot2c_f32_bf16 v133, s78, v153
    v_dot2c_f32_bf16 v134, s78, v154
    v_dot2c_f32_bf16 v135, s78, v155
    ds_read_b64_tr_b16 v[152:153], v43 offset:49152
    ds_read_b64_tr_b16 v[154:155], v43 offset:50176
    s_waitcnt lgkmcnt(10)
    v_dot2c_f32_bf16 v132, s78, v156
    v_dot2c_f32_bf16 v133, s78, v157
    v_dot2c_f32_bf16 v134, s78, v158
    v_dot2c_f32_bf16 v135, s78, v159
    ds_read_b64_tr_b16 v[156:157], v43 offset:51200
    ds_read_b64_tr_b16 v[158:159], v43 offset:52224
    s_waitcnt lgkmcnt(10)
    v_dot2c_f32_bf16 v132, s78, v136
    v_dot2c_f32_bf16 v133, s78, v137
    v_dot2c_f32_bf16 v134, s78, v138
    v_dot2c_f32_bf16 v135, s78, v139
    ds_read_b64_tr_b16 v[136:137], v43 offset:57344
    ds_read_b64_tr_b16 v[138:139], v43 offset:58368
    s_waitcnt lgkmcnt(10)
    v_dot2c_f32_bf16 v132, s78, v140
    v_dot2c_f32_bf16 v133, s78, v141
    v_dot2c_f32_bf16 v134, s78, v142
    v_dot2c_f32_bf16 v135, s78, v143
    ds_read_b64_tr_b16 v[140:141], v43 offset:59392
    ds_read_b64_tr_b16 v[142:143], v43 offset:60416
    s_waitcnt lgkmcnt(10)
    v_dot2c_f32_bf16 v132, s78, v144
    v_dot2c_f32_bf16 v133, s78, v145
    v_dot2c_f32_bf16 v134, s78, v146
    v_dot2c_f32_bf16 v135, s78, v147
    s_waitcnt lgkmcnt(8)
    v_dot2c_f32_bf16 v132, s78, v148
    v_dot2c_f32_bf16 v133, s78, v149
    v_dot2c_f32_bf16 v134, s78, v150
    v_dot2c_f32_bf16 v135, s78, v151
    s_waitcnt lgkmcnt(6)
    v_dot2c_f32_bf16 v132, s78, v152
    v_dot2c_f32_bf16 v133, s78, v153
    v_dot2c_f32_bf16 v134, s78, v154
    v_dot2c_f32_bf16 v135, s78, v155
    s_waitcnt lgkmcnt(4)
    v_dot2c_f32_bf16 v132, s78, v156
    v_dot2c_f32_bf16 v133, s78, v157
    v_dot2c_f32_bf16 v134, s78, v158
    v_dot2c_f32_bf16 v135, s78, v159
    s_waitcnt lgkmcnt(2)
    v_dot2c_f32_bf16 v132, s78, v136
    v_dot2c_f32_bf16 v133, s78, v137
    v_dot2c_f32_bf16 v134, s78, v138
    v_dot2c_f32_bf16 v135, s78, v139
    s_waitcnt lgkmcnt(0)
    v_dot2c_f32_bf16 v132, s78, v140
    v_dot2c_f32_bf16 v133, s78, v141
    v_dot2c_f32_bf16 v134, s78, v142
    v_dot2c_f32_bf16 v135, s78, v143
    s_nop 0
    v_add_f32 v132, v132, v133
    s_nop 0
    v_add_f32 v134, v134, v135
    v_add_f32 v132, v132, v134
    s_lshl_b32 s58, s48, 8
    s_add_u32 s58, s58, 157184
    v_lshlrev_b32 v54, 2, v1
    v_add_u32 v54, s58, v54
    ds_write_b32 v54, v132
    s_waitcnt lgkmcnt(0)
    v_mov_b32 v46, v8
    v_add_u32 v47, 69632, v8
    v_mov_b32 v48, v9
    v_add_u32 v49, 69632, v9
    s_lshl_b32 s58, s51, 2
    s_add_u32 s58, s58, s48
    s_lshl_b32 s58, s58, 15
    s_add_u32 s71, s58, 3145728
    s_lshl_b32 s58, s51, 7
    s_lshl_b32 s59, s48, 5
    s_add_u32 s58, s58, s59
    s_lshl_b32 s58, s58, 3
    s_add_u32 s80, s58, 7340032
    v_lshlrev_b32 v44, 17, v3
    v_lshlrev_b32 v55, 3, v2
    v_add_u32 v44, v44, v55
    s_barrier
    v_lshlrev_b32 v56, 2, v1
    v_add_u32 v56, 157184, v56
    ds_read_b32 v152, v56 offset:0
    ds_read_b32 v153, v56 offset:256
    ds_read_b32 v154, v56 offset:512
    ds_read_b32 v155, v56 offset:768
    s_waitcnt lgkmcnt(0)
    v_cvt_pk_bf16_f32 v54, v152, v152
    v_and_b32 v54, 0xffff0000, v54
    v_sub_f32 v54, v152, v54
    v_cvt_pk_bf16_f32 v160, v152, v54
    v_mov_b32 v161, v160
    v_mov_b32 v162, 0
    v_mov_b32 v163, 0
    v_cvt_pk_bf16_f32 v54, v153, v153
    v_and_b32 v54, 0xffff0000, v54
    v_sub_f32 v54, v153, v54
    v_cvt_pk_bf16_f32 v164, v153, v54
    v_mov_b32 v165, v164
    v_mov_b32 v166, 0
    v_mov_b32 v167, 0
    v_cvt_pk_bf16_f32 v54, v154, v154
    v_and_b32 v54, 0xffff0000, v54
    v_sub_f32 v54, v154, v54
    v_cvt_pk_bf16_f32 v168, v154, v54
    v_mov_b32 v169, v168
    v_mov_b32 v170, 0
    v_mov_b32 v171, 0
    v_cvt_pk_bf16_f32 v54, v155, v155
    v_and_b32 v54, 0xffff0000, v54
    v_sub_f32 v54, v155, v54
    v_cvt_pk_bf16_f32 v172, v155, v54
    v_mov_b32 v173, v172
    v_mov_b32 v174, 0
    v_mov_b32 v175, 0
    ds_read_b64_tr_b16 v[192:193], v46 offset:0
    ds_read_b64_tr_b16 v[194:195], v46 offset:1024
    ds_read_b64_tr_b16 v[196:197], v48 offset:0
    ds_read_b64_tr_b16 v[198:199], v48 offset:1024
    ds_read_b64_tr_b16 v[200:201], v46 offset:4096
    ds_read_b64_tr_b16 v[202:203], v46 offset:5120
    ds_read_b64_tr_b16 v[204:205], v48 offset:4096
    ds_read_b64_tr_b16 v[206:207], v48 offset:5120
    ds_read_b64_tr_b16 v[208:209], v46 offset:2048
    ds_read_b64_tr_b16 v[210:211], v46 offset:3072
    ds_read_b64_tr_b16 v[212:213], v48 offset:2048
    ds_read_b64_tr_b16 v[214:215], v48 offset:3072
    ds_read_b64_tr_b16 v[216:217], v46 offset:6144
    ds_read_b64_tr_b16 v[218:219], v46 offset:7168
    ds_read_b64_tr_b16 v[220:221], v48 offset:6144
    ds_read_b64_tr_b16 v[222:223], v48 offset:7168
    s_waitcnt vmcnt(0)
    s_mov_b32 s93, 0x40000
Lfw24:
    v_cmp_ne_u32 vcc, s53, v63
    s_nop 4
    s_cbranch_vccz Lfwo25
    s_sub_u32 s93, s93, 1
    s_cmp_eq_u32 s93, 0
    s_cbranch_scc1 Lfwo25
    v_min_u32 v55, 15, v1
    v_lshlrev_b32 v55, 2, v55
    buffer_load_dword v63, v55, s[40:43], s79 offen sc1
    s_waitcnt vmcnt(0)
    s_branch Lfw24
Lfwo25:
    s_add_u32 s64, s80, 0
    buffer_load_dwordx2 v[136:137], v44, s[40:43], s64 offen sc1
    s_add_u32 s64, s80, 16384
    buffer_load_dwordx2 v[138:139], v44, s[40:43], s64 offen sc1
    s_add_u32 s64, s80, 32768
    buffer_load_dwordx2 v[140:141], v44, s[40:43], s64 offen sc1
    s_add_u32 s64, s80, 49152
    buffer_load_dwordx2 v[142:143], v44, s[40:43], s64 offen sc1
    s_add_u32 s64, s80, 65536
    buffer_load_dwordx2 v[144:145], v44, s[40:43], s64 offen sc1
    s_add_u32 s64, s80, 81920
    buffer_load_dwordx2 v[146:147], v44, s[40:43], s64 offen sc1
    s_add_u32 s64, s80, 98304
    buffer_load_dwordx2 v[148:149], v44, s[40:43], s64 offen sc1
    s_add_u32 s64, s80, 114688
    buffer_load_dwordx2 v[150:151], v44, s[40:43], s64 offen sc1
    s_add_u32 s64, s71, 0
    buffer_load_dwordx4 a[0:3], v4, s[40:43], s64 offen offset:0 sc1
    buffer_load_dwordx4 a[4:7], v4, s[40:43], s64 offen offset:1024 sc1
    buffer_load_dwordx4 a[8:11], v4, s[40:43], s64 offen offset:2048 sc1
    buffer_load_dwordx4 a[12:15], v4, s[40:43], s64 offen offset:3072 sc1
    s_add_u32 s64, s71, 4096
    buffer_load_dwordx4 a[16:19], v4, s[40:43], s64 offen offset:0 sc1
    buffer_load_dwordx4 a[20:23], v4, s[40:43], s64 offen offset:1024 sc1
    s_waitcnt vmcnt(6)
    v_pk_add_f32 v[136:137], v[136:137], v[138:139]
    v_pk_add_f32 v[136:137], v[136:137], v[140:141]
    v_pk_add_f32 v[136:137], v[136:137], v[142:143]
    v_pk_add_f32 v[136:137], v[136:137], v[144:145]
    v_pk_add_f32 v[136:137], v[136:137], v[146:147]
    v_pk_add_f32 v[136:137], v[136:137], v[148:149]
    v_pk_add_f32 v[136:137], v[136:137], v[150:151]
    v_mov_b32 v54, v136
    s_nop 1
    v_permlane32_swap_b32 v136, v54
    v_add_f32 v136, v136, v54
    v_mov_b32 v54, v137
    s_nop 1
    v_permlane32_swap_b32 v137, v54
    v_add_f32 v137, v137, v54
    v_mul_f32 v240, 0xbb000000, v136
    v_mul_f32 v54, 0x3b000000, v137
    v_fma_f32 v54, -v240, v240, v54
    v_max_f32 v54, 0, v54
    v_add_f32 v54, 0x3727c5ac, v54
    v_rsq_f32 v242, v54
    v_cvt_pk_bf16_f32 v176, v240, v240
    v_and_b32 v54, 0xffff0000, v176
    v_sub_f32 v54, v240, v54
    v_cvt_pk_bf16_f32 v177, v54, v54
    v_mov_b32 v178, 0
    v_mov_b32 v179, 0
    s_nop 1
    v_mfma_f32_32x32x16_bf16 v[64:79], v[160:163], v[176:179], 0
    buffer_load_dwordx4 a[24:27], v4, s[40:43], s64 offen offset:2048 sc1
    v_mfma_f32_32x32x16_bf16 v[80:95], v[164:167], v[176:179], 0
    buffer_load_dwordx4 a[28:31], v4, s[40:43], s64 offen offset:3072 sc1
    v_mfma_f32_32x32x16_bf16 v[96:111], v[168:171], v[176:179], 0
    s_add_u32 s64, s71, 8192
    buffer_load_dwordx4 a[32:35], v4, s[40:43], s64 offen offset:0 sc1
    v_mfma_f32_32x32x16_bf16 v[112:127], v[172:175], v[176:179], 0
    buffer_load_dwordx4 a[36:39], v4, s[40:43], s64 offen offset:1024 sc1
    s_waitcnt lgkmcnt(8)
    s_waitcnt vmcnt(9)
    v_mfma_f32_32x32x16_bf16 v[64:79], v[192:195], a[0:3], v[64:79]
    ds_read_b64_tr_b16 v[224:225], v46 offset:8192
    ds_read_b64_tr_b16 v[226:227], v46 offset:9216
    buffer_load_dwordx4 a[40:43], v4, s[40:43], s64 offen offset:2048 sc1
    v_mfma_f32_32x32x16_bf16 v[80:95], v[196:199], a[0:3], v[80:95]
    ds_read_b64_tr_b16 v[228:229], v48 offset:8192
    ds_read_b64_tr_b16 v[230:231], v48 offset:9216
    v_mfma_f32_32x32x16_bf16 v[96:111], v[200:203], a[0:3], v[96:111]
    ds_read_b64_tr_b16 v[232:233], v46 offset:12288
    buffer_load_dwordx4 a[44:47], v4, s[40:43], s64 offen offset:3072 sc1
    ds_read_b64_tr_b16 v[234:235], v46 offset:13312
    v_mfma_f32_32x32x16_bf16 v[112:127], v[204:207], a[0:3], v[112:127]
    ds_read_b64_tr_b16 v[236:237], v48 offset:12288
    ds_read_b64_tr_b16 v[238:239], v48 offset:13312
    s_waitcnt lgkmcnt(8)
    s_waitcnt vmcnt(10)
    v_mfma_f32_32x32x16_bf16 v[64:79], v[208:211], a[4:7], v[64:79]
    ds_read_b64_tr_b16 v[192:193], v46 offset:10240
    ds_read_b64_tr_b16 v[194:195], v46 offset:11264
    s_add_u32 s64, s71, 12288
    buffer_load_dwordx4 a[48:51], v4, s[40:43], s64 offen offset:0 sc1
    v_mfma_f32_32x32x16_bf16 v[80:95], v[212:215], a[4:7], v[80:95]
    ds_read_b64_tr_b16 v[196:197], v48 offset:10240
    ds_read_b64_tr_b16 v[198:199], v48 offset:11264
    v_mfma_f32_32x32x16_bf16 v[96:111], v[216:219], a[4:7], v[96:111]
    ds_read_b64_tr_b16 v[200:201], v46 offset:14336
    buffer_load_dwordx4 a[52:55], v4, s[40:43], s64 offen offset:1024 sc1
    ds_read_b64_tr_b16 v[202:203], v46 offset:15360
    v_mfma_f32_32x32x16_bf16 v[112:127], v[220:223], a[4:7], v[112:127]
    ds_read_b64_tr_b16 v[204:205], v48 offset:14336
    ds_read_b64_tr_b16 v[206:207], v48 offset:15360
    s_waitcnt lgkmcnt(8)
    s_waitcnt vmcnt(11)
    v_mfma_f32_32x32x16_bf16 v[64:79], v[224:227], a[8:11], v[64:79]
    ds_read_b64_tr_b16 v[208:209], v46 offset:16384
    ds_read_b64_tr_b16 v[210:211], v46 offset:17408
    buffer_load_dwordx4 a[56:59], v4, s[40:43], s64 offen offset:2048 sc1
    v_mfma_f32_32x32x16_bf16 v[80:95], v[228:231], a[8:11], v[80:95]
    ds_read_b64_tr_b16 v[212:213], v48 offset:16384
    ds_read_b64_tr_b16 v[214:215], v48 offset:17408
    v_mfma_f32_32x32x16_bf16 v[96:111], v[232:235], a[8:11], v[96:111]
    ds_read_b64_tr_b16 v[216:217], v46 offset:20480
    buffer_load_dwordx4 a[60:63], v4, s[40:43], s64 offen offset:3072 sc1
    ds_read_b64_tr_b16 v[218:219], v46 offset:21504
    v_mfma_f32_32x32x16_bf16 v[112:127], v[236:239], a[8:11], v[112:127]
    ds_read_b64_tr_b16 v[220:221], v48 offset:20480
    ds_read_b64_tr_b16 v[222:223], v48 offset:21504
    s_waitcnt lgkmcnt(8)
    s_waitcnt vmcnt(12)
    v_mfma_f32_32x32x16_bf16 v[64:79], v[192:195], a[12:15], v[64:79]
    ds_read_b64_tr_b16 v[224:225], v46 offset:18432
    ds_read_b64_tr_b16 v[226:227], v46 offset:19456
    s_add_u32 s64, s71, 16384
    buffer_load_dwordx4 a[64:67], v4, s[40:43], s64 offen offset:0 sc1
    v_mfma_f32_32x32x16_bf16 v[80:95], v[196:199], a[12:15], v[80:95]
    ds_read_b64_tr_b16 v[228:229], v48 offset:18432
    ds_read_b64_tr_b16 v[230:231], v48 offset:19456
    v_mfma_f32_32x32x16_bf16 v[96:111], v[200:203], a[12:15], v[96:111]
    ds_read_b64_tr_b16 v[232:233], v46 offset:22528
    buffer_load_dwordx4 a[68:71], v4, s[40:43], s64 offen offset:1024 sc1
    ds_read_b64_tr_b16 v[234:235], v46 offset:23552
    v_mfma_f32_32x32x16_bf16 v[112:127], v[204:207], a[12:15], v[112:127]
    ds_read_b64_tr_b16 v[236:237], v48 offset:22528
    ds_read_b64_tr_b16 v[238:239], v48 offset:23552
    s_waitcnt lgkmcnt(8)
    s_waitcnt vmcnt(13)
    v_mfma_f32_32x32x16_bf16 v[64:79], v[208:211], a[16:19], v[64:79]
    ds_read_b64_tr_b16 v[192:193], v46 offset:24576
    ds_read_b64_tr_b16 v[194:195], v46 offset:25600
    buffer_load_dwordx4 a[72:75], v4, s[40:43], s64 offen offset:2048 sc1
    v_mfma_f32_32x32x16_bf16 v[80:95], v[212:215], a[16:19], v[80:95]
    ds_read_b64_tr_b16 v[196:197], v48 offset:24576
    ds_read_b64_tr_b16 v[198:199], v48 offset:25600
    v_mfma_f32_32x32x16_bf16 v[96:111], v[216:219], a[16:19], v[96:111]
    ds_read_b64_tr_b16 v[200:201], v46 offset:28672
    buffer_load_dwordx4 a[76:79], v4, s[40:43], s64 offen offset:3072 sc1
    ds_read_b64_tr_b16 v[202:203], v46 offset:29696
    v_mfma_f32_32x32x16_bf16 v[112:127], v[220:223], a[16:19], v[112:127]
    ds_read_b64_tr_b16 v[204:205], v48 offset:28672
    ds_read_b64_tr_b16 v[206:207], v48 offset:29696
    s_waitcnt lgkmcnt(8)
    s_waitcnt vmcnt(14)
    v_mfma_f32_32x32x16_bf16 v[64:79], v[224:227], a[20:23], v[64:79]
    ds_read_b64_tr_b16 v[208:209], v46 offset:26624
    ds_read_b64_tr_b16 v[210:211], v46 offset:27648
    s_add_u32 s64, s71, 20480
    buffer_load_dwordx4 a[80:83], v4, s[40:43], s64 offen offset:0 sc1
    v_mfma_f32_32x32x16_bf16 v[80:95], v[228:231], a[20:23], v[80:95]
    ds_read_b64_tr_b16 v[212:213], v48 offset:26624
    ds_read_b64_tr_b16 v[214:215], v48 offset:27648
    v_mfma_f32_32x32x16_bf16 v[96:111], v[232:235], a[20:23], v[96:111]
    ds_read_b64_tr_b16 v[216:217], v46 offset:30720
    buffer_load_dwordx4 a[84:87], v4, s[40:43], s64 offen offset:1024 sc1
    ds_read_b64_tr_b16 v[218:219], v46 offset:31744
    v_mfma_f32_32x32x16_bf16 v[112:127], v[236:239], a[20:23], v[112:127]
    ds_read_b64_tr_b16 v[220:221], v48 offset:30720
    ds_read_b64_tr_b16 v[222:223], v48 offset:31744
    s_waitcnt lgkmcnt(8)
    s_waitcnt vmcnt(15)
    v_mfma_f32_32x32x16_bf16 v[64:79], v[192:195], a[24:27], v[64:79]
    ds_read_b64_tr_b16 v[224:225], v46 offset:32768
    ds_read_b64_tr_b16 v[226:227], v46 offset:33792
    buffer_load_dwordx4 a[88:91], v4, s[40:43], s64 offen offset:2048 sc1
    v_mfma_f32_32x32x16_bf16 v[80:95], v[196:199], a[24:27], v[80:95]
    ds_read_b64_tr_b16 v[228:229], v48 offset:32768
    ds_read_b64_tr_b16 v[230:231], v48 offset:33792
    v_mfma_f32_32x32x16_bf16 v[96:111], v[200:203], a[24:27], v[96:111]
    ds_read_b64_tr_b16 v[232:233], v46 offset:36864
    buffer_load_dwordx4 a[92:95], v4, s[40:43], s64 offen offset:3072 sc1
    ds_read_b64_tr_b16 v[234:235], v46 offset:37888
    v_mfma_f32_32x32x16_bf16 v[112:127], v[204:207], a[24:27], v[112:127]
    ds_read_b64_tr_b16 v[236:237], v48 offset:36864
    ds_read_b64_tr_b16 v[238:239], v48 offset:37888
    s_waitcnt lgkmcnt(8)
    s_waitcnt vmcnt(16)
    v_mfma_f32_32x32x16_bf16 v[64:79], v[208:211], a[28:31], v[64:79]
    ds_read_b64_tr_b16 v[192:193], v46 offset:34816
    ds_read_b64_tr_b16 v[194:195], v46 offset:35840
    s_add_u32 s64, s71, 24576
    buffer_load_dwordx4 a[96:99], v4, s[40:43], s64 offen offset:0 sc1
    v_mfma_f32_32x32x16_bf16 v[80:95], v[212:215], a[28:31], v[80:95]
    ds_read_b64_tr_b16 v[196:197], v48 offset:34816
    ds_read_b64_tr_b16 v[198:199], v48 offset:35840
    v_mfma_f32_32x32x16_bf16 v[96:111], v[216:219], a[28:31], v[96:111]
    ds_read_b64_tr_b16 v[200:201], v46 offset:38912
    buffer_load_dwordx4 a[100:103], v4, s[40:43], s64 offen offset:1024 sc1
    ds_read_b64_tr_b16 v[202:203], v46 offset:39936
    v_mfma_f32_32x32x16_bf16 v[112:127], v[220:223], a[28:31], v[112:127]
    ds_read_b64_tr_b16 v[204:205], v48 offset:38912
    ds_read_b64_tr_b16 v[206:207], v48 offset:39936
    s_waitcnt lgkmcnt(8)
    s_waitcnt vmcnt(17)
    v_mfma_f32_32x32x16_bf16 v[64:79], v[224:227], a[32:35], v[64:79]
    ds_read_b64_tr_b16 v[208:209], v46 offset:40960
    ds_read_b64_tr_b16 v[210:211], v46 offset:41984
    buffer_load_dwordx4 a[104:107], v4, s[40:43], s64 offen offset:2048 sc1
    v_mfma_f32_32x32x16_bf16 v[80:95], v[228:231], a[32:35], v[80:95]
    ds_read_b64_tr_b16 v[212:213], v48 offset:40960
    ds_read_b64_tr_b16 v[214:215], v48 offset:41984
    v_mfma_f32_32x32x16_bf16 v[96:111], v[232:235], a[32:35], v[96:111]
    ds_read_b64_tr_b16 v[216:217], v46 offset:45056
    buffer_load_dwordx4 a[108:111], v4, s[40:43], s64 offen offset:3072 sc1
    ds_read_b64_tr_b16 v[218:219], v46 offset:46080
    v_mfma_f32_32x32x16_bf16 v[112:127], v[236:239], a[32:35], v[112:127]
    ds_read_b64_tr_b16 v[220:221], v48 offset:45056
    ds_read_b64_tr_b16 v[222:223], v48 offset:46080
    s_waitcnt lgkmcnt(8)
    s_waitcnt vmcnt(18)
    v_mfma_f32_32x32x16_bf16 v[64:79], v[192:195], a[36:39], v[64:79]
    ds_read_b64_tr_b16 v[224:225], v46 offset:43008
    ds_read_b64_tr_b16 v[226:227], v46 offset:44032
    s_add_u32 s64, s71, 28672
    buffer_load_dwordx4 a[112:115], v4, s[40:43], s64 offen offset:0 sc1
    v_mfma_f32_32x32x16_bf16 v[80:95], v[196:199], a[36:39], v[80:95]
    ds_read_b64_tr_b16 v[228:229], v48 offset:43008
    ds_read_b64_tr_b16 v[230:231], v48 offset:44032
    v_mfma_f32_32x32x16_bf16 v[96:111], v[200:203], a[36:39], v[96:111]
    ds_read_b64_tr_b16 v[232:233], v46 offset:47104
    buffer_load_dwordx4 a[116:119], v4, s[40:43], s64 offen offset:1024 sc1
    ds_read_b64_tr_b16 v[234:235], v46 offset:48128
    v_mfma_f32_32x32x16_bf16 v[112:127], v[204:207], a[36:39], v[112:127]
    ds_read_b64_tr_b16 v[236:237], v48 offset:47104
    ds_read_b64_tr_b16 v[238:239], v48 offset:48128
    s_waitcnt lgkmcnt(8)
    s_waitcnt vmcnt(19)
    v_mfma_f32_32x32x16_bf16 v[64:79], v[208:211], a[40:43], v[64:79]
    ds_read_b64_tr_b16 v[192:193], v46 offset:49152
    ds_read_b64_tr_b16 v[194:195], v46 offset:50176
    buffer_load_dwordx4 a[120:123], v4, s[40:43], s64 offen offset:2048 sc1
    v_mfma_f32_32x32x16_bf16 v[80:95], v[212:215], a[40:43], v[80:95]
    ds_read_b64_tr_b16 v[196:197], v48 offset:49152
    ds_read_b64_tr_b16 v[198:199], v48 offset:50176
    v_mfma_f32_32x32x16_bf16 v[96:111], v[216:219], a[40:43], v[96:111]
    ds_read_b64_tr_b16 v[200:201], v46 offset:53248
    buffer_load_dwordx4 a[124:127], v4, s[40:43], s64 offen offset:3072 sc1
    ds_read_b64_tr_b16 v[202:203], v46 offset:54272
    v_mfma_f32_32x32x16_bf16 v[112:127], v[220:223], a[40:43], v[112:127]
    ds_read_b64_tr_b16 v[204:205], v48 offset:53248
    ds_read_b64_tr_b16 v[206:207], v48 offset:54272
    s_waitcnt lgkmcnt(8)
    s_waitcnt vmcnt(20)
    v_mfma_f32_32x32x16_bf16 v[64:79], v[224:227], a[44:47], v[64:79]
    ds_read_b64_tr_b16 v[208:209], v46 offset:51200
    ds_read_b64_tr_b16 v[210:211], v46 offset:52224
    s_lshl_b32 s64, s67, 2
    s_add_u32 s64, s64, s48
    s_lshl_b32 s64, s64, 11
    s_add_u32 s64, s64, 262144
    s_mov_b64 exec, 0xffff
    buffer_load_dword v27, v5, s[32:35], s64 offen
    s_mov_b64 exec, -1
    v_mfma_f32_32x32x16_bf16 v[80:95], v[228:231], a[44:47], v[80:95]
    ds_read_b64_tr_b16 v[212:213], v48 offset:51200
    ds_read_b64_tr_b16 v[214:215], v48 offset:52224
    v_mfma_f32_32x32x16_bf16 v[96:111], v[232:235], a[44:47], v[96:111]
    ds_read_b64_tr_b16 v[216:217], v46 offset:55296
    s_lshl_b32 s64, s67, 2
    s_add_u32 s64, s64, s48
    s_lshl_b32 s64, s64, 11
    s_add_u32 s64, s64, 524288
    s_mov_b64 exec, 0xffff
    buffer_load_dword v27, v5, s[32:35], s64 offen
    s_mov_b64 exec, -1
    ds_read_b64_tr_b16 v[218:219], v46 offset:56320
    v_mfma_f32_32x32x16_bf16 v[112:127], v[236:239], a[44:47], v[112:127]
    ds_read_b64_tr_b16 v[220:221], v48 offset:55296
    ds_read_b64_tr_b16 v[222:223], v48 offset:56320
    s_waitcnt lgkmcnt(8)
    s_waitcnt vmcnt(21)
    v_mfma_f32_32x32x16_bf16 v[64:79], v[192:195], a[48:51], v[64:79]
    ds_read_b64_tr_b16 v[224:225], v46 offset:57344
    ds_read_b64_tr_b16 v[226:227], v46 offset:58368
    v_mfma_f32_32x32x16_bf16 v[80:95], v[196:199], a[48:51], v[80:95]
    ds_read_b64_tr_b16 v[228:229], v48 offset:57344
    ds_read_b64_tr_b16 v[230:231], v48 offset:58368
    v_mfma_f32_32x32x16_bf16 v[96:111], v[200:203], a[48:51], v[96:111]
    ds_read_b64_tr_b16 v[232:233], v46 offset:61440
    s_lshl_b32 s64, s67, 2
    s_add_u32 s64, s64, s48
    s_lshl_b32 s64, s64, 11
    s_add_u32 s64, s64, 786432
    s_mov_b64 exec, 0xffff
    buffer_load_dword v27, v5, s[32:35], s64 offen
    s_mov_b64 exec, -1
    ds_read_b64_tr_b16 v[234:235], v46 offset:62464
    v_mfma_f32_32x32x16_bf16 v[112:127], v[204:207], a[48:51], v[112:127]
    ds_read_b64_tr_b16 v[236:237], v48 offset:61440
    ds_read_b64_tr_b16 v[238:239], v48 offset:62464
    s_waitcnt lgkmcnt(8)
    s_waitcnt vmcnt(21)
    v_mfma_f32_32x32x16_bf16 v[64:79], v[208:211], a[52:55], v[64:79]
    ds_read_b64_tr_b16 v[192:193], v46 offset:59392
    ds_read_b64_tr_b16 v[194:195], v46 offset:60416
    v_mfma_f32_32x32x16_bf16 v[80:95], v[212:215], a[52:55], v[80:95]
    ds_read_b64_tr_b16 v[196:197], v48 offset:59392
    ds_read_b64_tr_b16 v[198:199], v48 offset:60416
    v_mfma_f32_32x32x16_bf16 v[96:111], v[216:219], a[52:55], v[96:111]
    ds_read_b64_tr_b16 v[200:201], v46 offset:63488
    ds_read_b64_tr_b16 v[202:203], v46 offset:64512
    v_mfma_f32_32x32x16_bf16 v[112:127], v[220:223], a[52:55], v[112:127]
    ds_read_b64_tr_b16 v[204:205], v48 offset:63488
    ds_read_b64_tr_b16 v[206:207], v48 offset:64512
    s_waitcnt lgkmcnt(8)
    s_waitcnt vmcnt(20)
    v_mfma_f32_32x32x16_bf16 v[64:79], v[224:227], a[56:59], v[64:79]
    ds_read_b64_tr_b16 v[208:209], v47 offset:0
    ds_read_b64_tr_b16 v[210:211], v47 offset:1024
    v_mfma_f32_32x32x16_bf16 v[80:95], v[228:231], a[56:59], v[80:95]
    ds_read_b64_tr_b16 v[212:213], v49 offset:0
    ds_read_b64_tr_b16 v[214:215], v49 offset:1024
    v_mfma_f32_32x32x16_bf16 v[96:111], v[232:235], a[56:59], v[96:111]
    ds_read_b64_tr_b16 v[216:217], v47 offset:4096
    ds_read_b64_tr_b16 v[218:219], v47 offset:5120
    v_mfma_f32_32x32x16_bf16 v[112:127], v[236:239], a[56:59], v[112:127]
    ds_read_b64_tr_b16 v[220:221], v49 offset:4096
    ds_read_b64_tr_b16 v[222:223], v49 offset:5120
    s_waitcnt lgkmcnt(8)
    s_waitcnt vmcnt(19)
    s_barrier
    s_cmp_eq_u32 s91, 0
    s_cselect_b64 vcc, -1, 0
    v_cndmask_b32 v42, v9, v8, vcc
    v_cndmask_b32 v43, v8, v9, vcc
    s_lshl_b32 s58, s48, 14
    v_add_u32 v38, s58, v42
    v_add_u32 v39, s58, v43
    v_add_u32 v40, 69632, v38
    v_add_u32 v41, 69632, v39
    s_lshl_b32 s58, s48, 12
    s_add_u32 s58, s58, 135168
    v_add_u32 v42, s58, v42
    v_add_u32 v43, s58, v43
    v_mfma_f32_32x32x16_bf16 v[64:79], v[192:195], a[60:63], v[64:79]
    ds_read_b64_tr_b16 v[224:225], v47 offset:2048
    ds_read_b64_tr_b16 v[226:227], v47 offset:3072
    s_lshl_b32 s64, s48, 14
    s_add_u32 m0, s64, 0
    s_lshl_b32 s64, s48, 15
    s_lshl_b32 s61, s50, 7
    s_add_u32 s64, s64, s61
    s_add_u32 s64, s64, 0
    buffer_load_dwordx4 v10, s[32:35], s64 offen lds
    v_mfma_f32_32x32x16_bf16 v[80:95], v[196:199], a[60:63], v[80:95]
    ds_read_b64_tr_b16 v[228:229], v49 offset:2048
    ds_read_b64_tr_b16 v[230:231], v49 offset:3072
    v_mfma_f32_32x32x16_bf16 v[96:111], v[200:203], a[60:63], v[96:111]
    ds_read_b64_tr_b16 v[232:233], v47 offset:6144
    buffer_load_dwordx4 v11, s[32:35], s64 offen offset:1024 lds
    ds_read_b64_tr_b16 v[234:235], v47 offset:7168
    v_mfma_f32_32x32x16_bf16 v[112:127], v[204:207], a[60:63], v[112:127]
    ds_read_b64_tr_b16 v[236:237], v49 offset:6144
    ds_read_b64_tr_b16 v[238:239], v49 offset:7168
    s_waitcnt lgkmcnt(8)
    s_waitcnt vmcnt(20)
    v_mfma_f32_32x32x16_bf16 v[64:79], v[208:211], a[64:67], v[64:79]
    ds_read_b64_tr_b16 v[192:193], v47 offset:8192
    ds_read_b64_tr_b16 v[194:195], v47 offset:9216
    buffer_load_dwordx4 v12, s[32:35], s64 offen offset:2048 lds
    v_mfma_f32_32x32x16_bf16 v[80:95], v[212:215], a[64:67], v[80:95]
    ds_read_b64_tr_b16 v[196:197], v49 offset:8192
    ds_read_b64_tr_b16 v[198:199], v49 offset:9216
    v_mfma_f32_32x32x16_bf16 v[96:111], v[216:219], a[64:67], v[96:111]
    ds_read_b64_tr_b16 v[200:201], v47 offset:12288
    buffer_load_dwordx4 v13, s[32:35], s64 offen offset:3072 lds
    ds_read_b64_tr_b16 v[202:203], v47 offset:13312
    v_mfma_f32_32x32x16_bf16 v[112:127], v[220:223], a[64:67], v[112:127]
    ds_read_b64_tr_b16 v[204:205], v49 offset:12288
    ds_read_b64_tr_b16 v[206:207], v49 offset:13312
    s_waitcnt lgkmcnt(8)
    s_waitcnt vmcnt(21)
    v_mfma_f32_32x32x16_bf16 v[64:79], v[224:227], a[68:71], v[64:79]
    ds_read_b64_tr_b16 v[208:209], v47 offset:10240
    ds_read_b64_tr_b16 v[210:211], v47 offset:11264
    s_lshl_b32 s64, s48, 14
    s_add_u32 m0, s64, 4096
    s_lshl_b32 s64, s48, 15
    s_lshl_b32 s61, s50, 7
    s_add_u32 s64, s64, s61
    s_add_u32 s64, s64, 131072
    buffer_load_dwordx4 v10, s[32:35], s64 offen lds
    v_mfma_f32_32x32x16_bf16 v[80:95], v[228:231], a[68:71], v[80:95]
    ds_read_b64_tr_b16 v[212:213], v49 offset:10240
    ds_read_b64_tr_b16 v[214:215], v49 offset:11264
    v_mfma_f32_32x32x16_bf16 v[96:111], v[232:235], a[68:71], v[96:111]
    ds_read_b64_tr_b16 v[216:217], v47 offset:14336
    buffer_load_dwordx4 v11, s[32:35], s64 offen offset:1024 lds
    ds_read_b64_tr_b16 v[218:219], v47 offset:15360
    v_mfma_f32_32x32x16_bf16 v[112:127], v[236:239], a[68:71], v[112:127]
    ds_read_b64_tr_b16 v[220:221], v49 offset:14336
    ds_read_b64_tr_b16 v[222:223], v49 offset:15360
    s_waitcnt lgkmcnt(8)
    s_waitcnt vmcnt(22)
    v_mfma_f32_32x32x16_bf16 v[64:79], v[192:195], a[72:75], v[64:79]
    ds_read_b64_tr_b16 v[224:225], v47 offset:16384
    ds_read_b64_tr_b16 v[226:227], v47 offset:17408
    buffer_load_dwordx4 v12, s[32:35], s64 offen offset:2048 lds
    v_mfma_f32_32x32x16_bf16 v[80:95], v[196:199], a[72:75], v[80:95]
    ds_read_b64_tr_b16 v[228:229], v49 offset:16384
    ds_read_b64_tr_b16 v[230:231], v49 offset:17408
    v_mfma_f32_32x32x16_bf16 v[96:111], v[200:203], a[72:75], v[96:111]
    ds_read_b64_tr_b16 v[232:233], v47 offset:20480
    buffer_load_dwordx4 v13, s[32:35], s64 offen offset:3072 lds
    ds_read_b64_tr_b16 v[234:235], v47 offset:21504
    v_mfma_f32_32x32x16_bf16 v[112:127], v[204:207], a[72:75], v[112:127]
    ds_read_b64_tr_b16 v[236:237], v49 offset:20480
    ds_read_b64_tr_b16 v[238:239], v49 offset:21504
    s_waitcnt lgkmcnt(8)
    s_waitcnt vmcnt(23)
    v_mfma_f32_32x32x16_bf16 v[64:79], v[208:211], a[76:79], v[64:79]
    ds_read_b64_tr_b16 v[192:193], v47 offset:18432
    ds_read_b64_tr_b16 v[194:195], v47 offset:19456
    s_lshl_b32 s64, s48, 14
    s_add_u32 m0, s64, 8192
    s_lshl_b32 s64, s48, 15
    s_lshl_b32 s61, s50, 7
    s_add_u32 s64, s64, s61
    s_add_u32 s64, s64, 262144
    buffer_load_dwordx4 v10, s[32:35], s64 offen lds
    v_mfma_f32_32x32x16_bf16 v[80:95], v[212:215], a[76:79], v[80:95]
    ds_read_b64_tr_b16 v[196:197], v49 offset:18432
    ds_read_b64_tr_b16 v[198:199], v49 offset:19456
    v_mfma_f32_32x32x16_bf16 v[96:111], v[216:219], a[76:79], v[96:111]
    ds_read_b64_tr_b16 v[200:201], v47 offset:22528
    buffer_load_dwordx4 v11, s[32:35], s64 offen offset:1024 lds
    ds_read_b64_tr_b16 v[202:203], v47 offset:23552
    v_mfma_f32_32x32x16_bf16 v[112:127], v[220:223], a[76:79], v[112:127]
    ds_read_b64_tr_b16 v[204:205], v49 offset:22528
    ds_read_b64_tr_b16 v[206:207], v49 offset:23552
    s_waitcnt lgkmcnt(8)
    s_waitcnt vmcnt(24)
    v_mfma_f32_32x32x16_bf16 v[64:79], v[224:227], a[80:83], v[64:79]
    ds_read_b64_tr_b16 v[208:209], v47 offset:24576
    ds_read_b64_tr_b16 v[210:211], v47 offset:25600
    buffer_load_dwordx4 v12, s[32:35], s64 offen offset:2048 lds
    v_mfma_f32_32x32x16_bf16 v[80:95], v[228:231], a[80:83], v[80:95]
    ds_read_b64_tr_b16 v[212:213], v49 offset:24576
    ds_read_b64_tr_b16 v[214:215], v49 offset:25600
    v_mfma_f32_32x32x16_bf16 v[96:111], v[232:235], a[80:83], v[96:111]
    ds_read_b64_tr_b16 v[216:217], v47 offset:28672
    buffer_load_dwordx4 v13, s[32:35], s64 offen offset:3072 lds
    ds_read_b64_tr_b16 v[218:219], v47 offset:29696
    v_mfma_f32_32x32x16_bf16 v[112:127], v[236:239], a[80:83], v[112:127]
    ds_read_b64_tr_b16 v[220:221], v49 offset:28672
    ds_read_b64_tr_b16 v[222:223], v49 offset:29696
    s_waitcnt lgkmcnt(8)
    s_waitcnt vmcnt(25)
    v_mfma_f32_32x32x16_bf16 v[64:79], v[192:195], a[84:87], v[64:79]
    ds_read_b64_tr_b16 v[224:225], v47 offset:26624
    ds_read_b64_tr_b16 v[226:227], v47 offset:27648
    s_lshl_b32 s64, s48, 14
    s_add_u32 m0, s64, 12288
    s_lshl_b32 s64, s48, 15
    s_lshl_b32 s61, s50, 7
    s_add_u32 s64, s64, s61
    s_add_u32 s64, s64, 393216
    buffer_load_dwordx4 v10, s[32:35], s64 offen lds
    v_mfma_f32_32x32x16_bf16 v[80:95], v[196:199], a[84:87], v[80:95]
    ds_read_b64_tr_b16 v[228:229], v49 offset:26624
    ds_read_b64_tr_b16 v[230:231], v49 offset:27648
    v_mfma_f32_32x32x16_bf16 v[96:111], v[200:203], a[84:87], v[96:111]
    ds_read_b64_tr_b16 v[232:233], v47 offset:30720
    buffer_load_dwordx4 v11, s[32:35], s64 offen offset:1024 lds
    ds_read_b64_tr_b16 v[234:235], v47 offset:31744
    v_mfma_f32_32x32x16_bf16 v[112:127], v[204:207], a[84:87], v[112:127]
    ds_read_b64_tr_b16 v[236:237], v49 offset:30720
    ds_read_b64_tr_b16 v[238:239], v49 offset:31744
    s_waitcnt lgkmcnt(8)
    s_waitcnt vmcnt(26)
    v_mfma_f32_32x32x16_bf16 v[64:79], v[208:211], a[88:91], v[64:79]
    ds_read_b64_tr_b16 v[192:193], v47 offset:32768
    ds_read_b64_tr_b16 v[194:195], v47 offset:33792
    buffer_load_dwordx4 v12, s[32:35], s64 offen offset:2048 lds
    v_mfma_f32_32x32x16_bf16 v[80:95], v[212:215], a[88:91], v[80:95]
    ds_read_b64_tr_b16 v[196:197], v49 offset:32768
    ds_read_b64_tr_b16 v[198:199], v49 offset:33792
    v_mfma_f32_32x32x16_bf16 v[96:111], v[216:219], a[88:91], v[96:111]
    ds_read_b64_tr_b16 v[200:201], v47 offset:36864
    buffer_load_dwordx4 v13, s[32:35], s64 offen offset:3072 lds
    ds_read_b64_tr_b16 v[202:203], v47 offset:37888
    v_mfma_f32_32x32x16_bf16 v[112:127], v[220:223], a[88:91], v[112:127]
    ds_read_b64_tr_b16 v[204:205], v49 offset:36864
    ds_read_b64_tr_b16 v[206:207], v49 offset:37888
    s_waitcnt lgkmcnt(8)
    s_waitcnt vmcnt(27)
    v_mfma_f32_32x32x16_bf16 v[64:79], v[224:227], a[92:95], v[64:79]
    ds_read_b64_tr_b16 v[208:209], v47 offset:34816
    ds_read_b64_tr_b16 v[210:211], v47 offset:35840
    s_lshl_b32 s64, s48, 12
    s_add_u32 m0, s64, 135168
    s_lshl_b32 s64, s48, 15
    s_lshl_b32 s61, s50, 7
    s_add_u32 s64, s64, s61
    s_add_u32 s64, s64, 524288
    buffer_load_dwordx4 v10, s[32:35], s64 offen lds
    v_mfma_f32_32x32x16_bf16 v[80:95], v[228:231], a[92:95], v[80:95]
    ds_read_b64_tr_b16 v[212:213], v49 offset:34816
    ds_read_b64_tr_b16 v[214:215], v49 offset:35840
    v_mfma_f32_32x32x16_bf16 v[96:111], v[232:235], a[92:95], v[96:111]
    ds_read_b64_tr_b16 v[216:217], v47 offset:38912
    buffer_load_dwordx4 v11, s[32:35], s64 offen offset:1024 lds
    ds_read_b64_tr_b16 v[218:219], v47 offset:39936
    v_mfma_f32_32x32x16_bf16 v[112:127], v[236:239], a[92:95], v[112:127]
    ds_read_b64_tr_b16 v[220:221], v49 offset:38912
    ds_read_b64_tr_b16 v[222:223], v49 offset:39936
    s_waitcnt lgkmcnt(8)
    s_waitcnt vmcnt(28)
    v_mfma_f32_32x32x16_bf16 v[64:79], v[192:195], a[96:99], v[64:79]
    ds_read_b64_tr_b16 v[224:225], v47 offset:40960
    ds_read_b64_tr_b16 v[226:227], v47 offset:41984
    buffer_load_dwordx4 v12, s[32:35], s64 offen offset:2048 lds
    v_mfma_f32_32x32x16_bf16 v[80:95], v[196:199], a[96:99], v[80:95]
    ds_read_b64_tr_b16 v[228:229], v49 offset:40960
    ds_read_b64_tr_b16 v[230:231], v49 offset:41984
    v_mfma_f32_32x32x16_bf16 v[96:111], v[200:203], a[96:99], v[96:111]
    ds_read_b64_tr_b16 v[232:233], v47 offset:45056
    buffer_load_dwordx4 v13, s[32:35], s64 offen offset:3072 lds
    ds_read_b64_tr_b16 v[234:235], v47 offset:46080
    v_mfma_f32_32x32x16_bf16 v[112:127], v[204:207], a[96:99], v[112:127]
    ds_read_b64_tr_b16 v[236:237], v49 offset:45056
    ds_read_b64_tr_b16 v[238:239], v49 offset:46080
    s_waitcnt lgkmcnt(8)
    s_waitcnt vmcnt(29)
    v_mfma_f32_32x32x16_bf16 v[64:79], v[208:211], a[100:103], v[64:79]
    ds_read_b64_tr_b16 v[192:193], v47 offset:43008
    ds_read_b64_tr_b16 v[194:195], v47 offset:44032
    s_lshl_b32 s64, s67, 2
    s_add_u32 s64, s64, s48
    s_lshl_b32 s64, s64, 11
    s_add_u32 s64, s64, 1048576
    s_mov_b64 exec, 0xffff
    buffer_load_dword v27, v5, s[32:35], s64 offen
    s_mov_b64 exec, -1
    v_mfma_f32_32x32x16_bf16 v[80:95], v[212:215], a[100:103], v[80:95]
    ds_read_b64_tr_b16 v[196:197], v49 offset:43008
    ds_read_b64_tr_b16 v[198:199], v49 offset:44032
    v_mfma_f32_32x32x16_bf16 v[96:111], v[216:219], a[100:103], v[96:111]
    ds_read_b64_tr_b16 v[200:201], v47 offset:47104
    s_lshl_b32 s64, s67, 2
    s_add_u32 s64, s64, s48
    s_lshl_b32 s64, s64, 11
    s_add_u32 s64, s64, 1310720
    s_mov_b64 exec, 0xffff
    buffer_load_dword v27, v5, s[32:35], s64 offen
    s_mov_b64 exec, -1
    ds_read_b64_tr_b16 v[202:203], v47 offset:48128
    v_mfma_f32_32x32x16_bf16 v[112:127], v[220:223], a[100:103], v[112:127]
    ds_read_b64_tr_b16 v[204:205], v49 offset:47104
    ds_read_b64_tr_b16 v[206:207], v49 offset:48128
    s_waitcnt lgkmcnt(8)
    s_waitcnt vmcnt(30)
    v_mfma_f32_32x32x16_bf16 v[64:79], v[224:227], a[104:107], v[64:79]
    ds_read_b64_tr_b16 v[208:209], v47 offset:49152
    ds_read_b64_tr_b16 v[210:211], v47 offset:50176
    s_lshl_b32 s64, s67, 2
    s_add_u32 s64, s64, s48
    s_lshl_b32 s64, s64, 11
    s_add_u32 s64, s64, 1572864
    s_mov_b64 exec, 0xffff
    buffer_load_dword v27, v5, s[32:35], s64 offen
    s_mov_b64 exec, -1
    v_mfma_f32_32x32x16_bf16 v[80:95], v[228:231], a[104:107], v[80:95]
    ds_read_b64_tr_b16 v[212:213], v49 offset:49152
    ds_read_b64_tr_b16 v[214:215], v49 offset:50176
    v_mfma_f32_32x32x16_bf16 v[96:111], v[232:235], a[104:107], v[96:111]
    ds_read_b64_tr_b16 v[216:217], v47 offset:53248
    ds_read_b64_tr_b16 v[218:219], v47 offset:54272
    v_mfma_f32_32x32x16_bf16 v[112:127], v[236:239], a[104:107], v[112:127]
    ds_read_b64_tr_b16 v[220:221], v49 offset:53248
    ds_read_b64_tr_b16 v[222:223], v49 offset:54272
    s_waitcnt lgkmcnt(8)
    s_waitcnt vmcnt(30)
    v_mfma_f32_32x32x16_bf16 v[64:79], v[192:195], a[108:111], v[64:79]
    ds_read_b64_tr_b16 v[224:225], v47 offset:51200
    ds_read_b64_tr_b16 v[226:227], v47 offset:52224
    v_mfma_f32_32x32x16_bf16 v[80:95], v[196:199], a[108:111], v[80:95]
    ds_read_b64_tr_b16 v[228:229], v49 offset:51200
    ds_read_b64_tr_b16 v[230:231], v49 offset:52224
    v_mfma_f32_32x32x16_bf16 v[96:111], v[200:203], a[108:111], v[96:111]
    ds_read_b64_tr_b16 v[232:233], v47 offset:55296
    ds_read_b64_tr_b16 v[234:235], v47 offset:56320
    v_mfma_f32_32x32x16_bf16 v[112:127], v[204:207], a[108:111], v[112:127]
    ds_read_b64_tr_b16 v[236:237], v49 offset:55296
    ds_read_b64_tr_b16 v[238:239], v49 offset:56320
    s_waitcnt lgkmcnt(8)
    s_waitcnt vmcnt(29)
    v_mfma_f32_32x32x16_bf16 v[64:79], v[208:211], a[112:115], v[64:79]
    ds_read_b64_tr_b16 v[192:193], v47 offset:57344
    ds_read_b64_tr_b16 v[194:195], v47 offset:58368
    v_mfma_f32_32x32x16_bf16 v[80:95], v[212:215], a[112:115], v[80:95]
    ds_read_b64_tr_b16 v[196:197], v49 offset:57344
    ds_read_b64_tr_b16 v[198:199], v49 offset:58368
    v_mfma_f32_32x32x16_bf16 v[96:111], v[216:219], a[112:115], v[96:111]
    ds_read_b64_tr_b16 v[200:201], v47 offset:61440
    ds_read_b64_tr_b16 v[202:203], v47 offset:62464
    v_mfma_f32_32x32x16_bf16 v[112:127], v[220:223], a[112:115], v[112:127]
    ds_read_b64_tr_b16 v[204:205], v49 offset:61440
    ds_read_b64_tr_b16 v[206:207], v49 offset:62464
    s_waitcnt lgkmcnt(8)
    s_waitcnt vmcnt(28)
    v_mfma_f32_32x32x16_bf16 v[64:79], v[224:227], a[116:119], v[64:79]
    ds_read_b64_tr_b16 v[208:209], v47 offset:59392
    ds_read_b64_tr_b16 v[210:211], v47 offset:60416
    v_mfma_f32_32x32x16_bf16 v[80:95], v[228:231], a[116:119], v[80:95]
    ds_read_b64_tr_b16 v[212:213], v49 offset:59392
    ds_read_b64_tr_b16 v[214:215], v49 offset:60416
    v_mfma_f32_32x32x16_bf16 v[96:111], v[232:235], a[116:119], v[96:111]
    ds_read_b64_tr_b16 v[216:217], v47 offset:63488
    ds_read_b64_tr_b16 v[218:219], v47 offset:64512
    v_mfma_f32_32x32x16_bf16 v[112:127], v[236:239], a[116:119], v[112:127]
    ds_read_b64_tr_b16 v[220:221], v49 offset:63488
    ds_read_b64_tr_b16 v[222:223], v49 offset:64512
    s_waitcnt lgkmcnt(8)
    s_waitcnt vmcnt(27)
    v_mfma_f32_32x32x16_bf16 v[64:79], v[192:195], a[120:123], v[64:79]
    v_mfma_f32_32x32x16_bf16 v[80:95], v[196:199], a[120:123], v[80:95]
    v_mfma_f32_32x32x16_bf16 v[96:111], v[200:203], a[120:123], v[96:111]
    v_mfma_f32_32x32x16_bf16 v[112:127], v[204:207], a[120:123], v[112:127]
    s_waitcnt lgkmcnt(0)
    s_waitcnt vmcnt(26)
    v_mfma_f32_32x32x16_bf16 v[64:79], v[208:211], a[124:127], v[64:79]
    v_mfma_f32_32x32x16_bf16 v[80:95], v[212:215], a[124:127], v[80:95]
    v_mfma_f32_32x32x16_bf16 v[96:111], v[216:219], a[124:127], v[96:111]
    v_mfma_f32_32x32x16_bf16 v[112:127], v[220:223], a[124:127], v[112:127]
L_b3end:
    s_barrier
    s_lshl_b32 s58, s51, 2
    s_add_u32 s58, s58, s48
    s_mul_i32 s58, s58, 112
    s_lshl_b32 s59, s52, 3
    s_add_u32 s58, s58, s59
    s_lshl_b32 s58, s58, 10
    s_add_u32 s71, s58, 16777216
    s_add_u32 s80, s71, 4096
    s_waitcnt vmcnt(3)
    s_mov_b32 s84, s80
    s_xor_b32 s57, s90, 1
    s_lshl_b32 s59, s48, 3
    s_lshl_b32 s58, s49, 1
    s_add_u32 s58, s58, s90
    s_mul_i32 s58, s58, 32
    s_add_u32 s58, s58, s59
    s_lshl_b32 s58, s58, 10
    s_add_u32 s80, s58, 5242880
    s_lshl_b32 s59, s48, 3
    s_lshl_b32 s58, s49, 1
    s_add_u32 s58, s58, s57
    s_mul_i32 s58, s58, 32
    s_add_u32 s58, s58, s59
    s_lshl_b32 s58, s58, 10
    s_add_u32 s81, s58, 5242880
    s_lshl_b32 s59, s48, 1
    s_lshl_b32 s58, s49, 1
    s_add_u32 s58, s58, s90
    s_mul_i32 s58, s58, 112
    s_add_u32 s58, s58, s59
    s_lshl_b32 s58, s58, 10
    s_add_u32 s82, s58, 16777216
    s_lshl_b32 s59, s48, 1
    s_lshl_b32 s58, s49, 1
    s_add_u32 s58, s58, s57
    s_mul_i32 s58, s58, 112
    s_add_u32 s58, s58, s59
    s_lshl_b32 s58, s58, 10
    s_add_u32 s83, s58, 16777216
    s_lshl_b32 s58, s48, 13
    s_add_u32 s70, s58, 7864320
    ds_read_b64_tr_b16 a[128:129], v38 offset:0
    ds_read_b64_tr_b16 a[130:131], v38 offset:1024
    ds_read_b64_tr_b16 a[132:133], v39 offset:0
    ds_read_b64_tr_b16 a[134:135], v39 offset:1024
    ds_read_b64_tr_b16 a[136:137], v38 offset:2048
    ds_read_b64_tr_b16 a[138:139], v38 offset:3072
    ds_read_b64_tr_b16 a[140:141], v39 offset:2048
    ds_read_b64_tr_b16 a[142:143], v39 offset:3072
    ds_read_b64_tr_b16 a[144:145], v38 offset:4096
    ds_read_b64_tr_b16 a[146:147], v38 offset:5120
    v_pk_mul_f32 v[64:65], v[64:65], v[242:243] op_sel_hi:[1,0]
    v_pk_mul_f32 v[66:67], v[66:67], v[242:243] op_sel_hi:[1,0]
    v_pk_mul_f32 v[68:69], v[68:69], v[242:243] op_sel_hi:[1,0]
    v_pk_mul_f32 v[70:71], v[70:71], v[242:243] op_sel_hi:[1,0]
    s_lshl_b32 s64, s48, 14
    s_add_u32 m0, s64, 69632
    s_mul_i32 s64, s48, 131072
    s_lshl_b32 s61, s50, 7
    s_add_u32 s64, s64, s61
    s_add_u32 s64, s64, 0
    buffer_load_dwordx4 v10, s[12:15], s64 offen lds
    v_pk_mul_f32 v[192:193], v[64:65], v[64:65]
    v_pk_mul_f32 v[194:195], v[66:67], v[66:67]
    v_pk_mul_f32 v[196:197], v[68:69], v[68:69]
    v_pk_mul_f32 v[198:199], v[70:71], v[70:71]
    buffer_load_dwordx4 v11, s[12:15], s64 offen offset:1024 lds
    v_pk_fma_f32 v[192:193], v[192:193], s[74:75], v[28:29]
    v_pk_fma_f32 v[194:195], v[194:195], s[74:75], v[28:29]
    v_pk_fma_f32 v[196:197], v[196:197], s[74:75], v[28:29]
    v_pk_fma_f32 v[198:199], v[198:199], s[74:75], v[28:29]
    buffer_load_dwordx4 v12, s[12:15], s64 offen offset:2048 lds
    v_pk_mul_f32 v[192:193], v[192:193], v[64:65]
    v_pk_mul_f32 v[194:195], v[194:195], v[66:67]
    v_pk_mul_f32 v[196:197], v[196:197], v[68:69]
    v_pk_mul_f32 v[198:199], v[198:199], v[70:71]
    v_exp_f32 v192, v192
    v_exp_f32 v193, v193
    v_exp_f32 v194, v194
    v_exp_f32 v195, v195
    v_exp_f32 v196, v196
    v_exp_f32 v197, v197
    v_exp_f32 v198, v198
    v_exp_f32 v199, v199
    v_pk_add_f32 v[192:193], v[192:193], 1.0 op_sel_hi:[1,0]
    v_pk_add_f32 v[194:195], v[194:195], 1.0 op_sel_hi:[1,0]
    v_pk_add_f32 v[196:197], v[196:197], 1.0 op_sel_hi:[1,0]
    v_pk_add_f32 v[198:199], v[198:199], 1.0 op_sel_hi:[1,0]
    v_rcp_f32 v192, v192
    v_rcp_f32 v193, v193
    v_rcp_f32 v194, v194
    v_rcp_f32 v195, v195
    v_rcp_f32 v196, v196
    v_rcp_f32 v197, v197
    v_rcp_f32 v198, v198
    v_rcp_f32 v199, v199
    v_pk_mul_f32 v[64:65], v[64:65], v[192:193]
    v_pk_mul_f32 v[66:67], v[66:67], v[194:195]
    v_pk_mul_f32 v[68:69], v[68:69], v[196:197]
    v_pk_mul_f32 v[70:71], v[70:71], v[198:199]
    v_cvt_pk_bf16_f32 v128, v64, v65
    v_cvt_pk_bf16_f32 v129, v66, v67
    v_cvt_pk_bf16_f32 v130, v68, v69
    v_cvt_pk_bf16_f32 v131, v70, v71
    v_pk_mul_f32 v[72:73], v[72:73], v[242:243] op_sel_hi:[1,0]
    v_pk_mul_f32 v[74:75], v[74:75], v[242:243] op_sel_hi:[1,0]
    v_pk_mul_f32 v[76:77], v[76:77], v[242:243] op_sel_hi:[1,0]
    v_pk_mul_f32 v[78:79], v[78:79], v[242:243] op_sel_hi:[1,0]
    buffer_load_dwordx4 v13, s[12:15], s64 offen offset:3072 lds
    v_pk_mul_f32 v[200:201], v[72:73], v[72:73]
    v_pk_mul_f32 v[202:203], v[74:75], v[74:75]
    v_pk_mul_f32 v[204:205], v[76:77], v[76:77]
    v_pk_mul_f32 v[206:207], v[78:79], v[78:79]
    s_add_u32 s64, s80, 0
    buffer_load_dwordx4 a[32:35], v4, s[40:43], s64 offen sc1
    v_pk_fma_f32 v[200:201], v[200:201], s[74:75], v[28:29]
    v_pk_fma_f32 v[202:203], v[202:203], s[74:75], v[28:29]
    v_pk_fma_f32 v[204:205], v[204:205], s[74:75], v[28:29]
    v_pk_fma_f32 v[206:207], v[206:207], s[74:75], v[28:29]
    s_add_u32 s64, s81, 0
    buffer_load_dwordx4 a[36:39], v4, s[40:43], s64 offen sc1
    v_pk_mul_f32 v[200:201], v[200:201], v[72:73]
    v_pk_mul_f32 v[202:203], v[202:203], v[74:75]
    v_pk_mul_f32 v[204:205], v[204:205], v[76:77]
    v_pk_mul_f32 v[206:207], v[206:207], v[78:79]
    v_exp_f32 v200, v200
    v_exp_f32 v201, v201
    v_exp_f32 v202, v202
    v_exp_f32 v203, v203
    v_exp_f32 v204, v204
    v_exp_f32 v205, v205
    v_exp_f32 v206, v206
    v_exp_f32 v207, v207
    v_pk_add_f32 v[200:201], v[200:201], 1.0 op_sel_hi:[1,0]
    v_pk_add_f32 v[202:203], v[202:203], 1.0 op_sel_hi:[1,0]
    v_pk_add_f32 v[204:205], v[204:205], 1.0 op_sel_hi:[1,0]
    v_pk_add_f32 v[206:207], v[206:207], 1.0 op_sel_hi:[1,0]
    v_rcp_f32 v200, v200
    v_rcp_f32 v201, v201
    v_rcp_f32 v202, v202
    v_rcp_f32 v203, v203
    v_rcp_f32 v204, v204
    v_rcp_f32 v205, v205
    v_rcp_f32 v206, v206
    v_rcp_f32 v207, v207
    v_pk_mul_f32 v[72:73], v[72:73], v[200:201]
    v_pk_mul_f32 v[74:75], v[74:75], v[202:203]
    v_pk_mul_f32 v[76:77], v[76:77], v[204:205]
    v_pk_mul_f32 v[78:79], v[78:79], v[206:207]
    v_cvt_pk_bf16_f32 v132, v72, v73
    v_cvt_pk_bf16_f32 v133, v74, v75
    v_cvt_pk_bf16_f32 v134, v76, v77
    v_cvt_pk_bf16_f32 v135, v78, v79
    buffer_store_dwordx4 v[128:131], v4, s[40:43], s71 offen offset:0 sc1
    buffer_store_dwordx4 v[132:135], v4, s[40:43], s71 offen offset:1024 sc1
    ds_read_b64_tr_b16 a[148:149], v39 offset:4096
    ds_read_b64_tr_b16 a[150:151], v39 offset:5120
    ds_read_b64_tr_b16 a[152:153], v38 offset:6144
    ds_read_b64_tr_b16 a[154:155], v38 offset:7168
    ds_read_b64_tr_b16 a[156:157], v39 offset:6144
    ds_read_b64_tr_b16 a[158:159], v39 offset:7168
    ds_read_b64_tr_b16 a[160:161], v38 offset:8192
    ds_read_b64_tr_b16 a[162:163], v38 offset:9216
    ds_read_b64_tr_b16 a[164:165], v39 offset:8192
    ds_read_b64_tr_b16 a[166:167], v39 offset:9216
    v_pk_mul_f32 v[80:81], v[80:81], v[242:243] op_sel_hi:[1,0]
    v_pk_mul_f32 v[82:83], v[82:83], v[242:243] op_sel_hi:[1,0]
    v_pk_mul_f32 v[84:85], v[84:85], v[242:243] op_sel_hi:[1,0]
    v_pk_mul_f32 v[86:87], v[86:87], v[242:243] op_sel_hi:[1,0]
    s_lshl_b32 s64, s48, 14
    s_add_u32 m0, s64, 73728
    s_mul_i32 s64, s48, 131072
    s_lshl_b32 s61, s50, 7
    s_add_u32 s64, s64, s61
    s_add_u32 s64, s64, 32768
    buffer_load_dwordx4 v10, s[12:15], s64 offen lds
    v_pk_mul_f32 v[192:193], v[80:81], v[80:81]
    v_pk_mul_f32 v[194:195], v[82:83], v[82:83]
    v_pk_mul_f32 v[196:197], v[84:85], v[84:85]
    v_pk_mul_f32 v[198:199], v[86:87], v[86:87]
    buffer_load_dwordx4 v11, s[12:15], s64 offen offset:1024 lds
    v_pk_fma_f32 v[192:193], v[192:193], s[74:75], v[28:29]
    v_pk_fma_f32 v[194:195], v[194:195], s[74:75], v[28:29]
    v_pk_fma_f32 v[196:197], v[196:197], s[74:75], v[28:29]
    v_pk_fma_f32 v[198:199], v[198:199], s[74:75], v[28:29]
    buffer_load_dwordx4 v12, s[12:15], s64 offen offset:2048 lds
    v_pk_mul_f32 v[192:193], v[192:193], v[80:81]
    v_pk_mul_f32 v[194:195], v[194:195], v[82:83]
    v_pk_mul_f32 v[196:197], v[196:197], v[84:85]
    v_pk_mul_f32 v[198:199], v[198:199], v[86:87]
    buffer_load_dwordx4 v13, s[12:15], s64 offen offset:3072 lds
    v_exp_f32 v192, v192
    v_exp_f32 v193, v193
    v_exp_f32 v194, v194
    v_exp_f32 v195, v195
    v_exp_f32 v196, v196
    v_exp_f32 v197, v197
    v_exp_f32 v198, v198
    v_exp_f32 v199, v199
    v_pk_add_f32 v[192:193], v[192:193], 1.0 op_sel_hi:[1,0]
    v_pk_add_f32 v[194:195], v[194:195], 1.0 op_sel_hi:[1,0]
    v_pk_add_f32 v[196:197], v[196:197], 1.0 op_sel_hi:[1,0]
    v_pk_add_f32 v[198:199], v[198:199], 1.0 op_sel_hi:[1,0]
    v_rcp_f32 v192, v192
    v_rcp_f32 v193, v193
    v_rcp_f32 v194, v194
    v_rcp_f32 v195, v195
    v_rcp_f32 v196, v196
    v_rcp_f32 v197, v197
    v_rcp_f32 v198, v198
    v_rcp_f32 v199, v199
    v_pk_mul_f32 v[80:81], v[80:81], v[192:193]
    v_pk_mul_f32 v[82:83], v[82:83], v[194:195]
    v_pk_mul_f32 v[84:85], v[84:85], v[196:197]
    v_pk_mul_f32 v[86:87], v[86:87], v[198:199]
    v_cvt_pk_bf16_f32 v136, v80, v81
    v_cvt_pk_bf16_f32 v137, v82, v83
    v_cvt_pk_bf16_f32 v138, v84, v85
    v_cvt_pk_bf16_f32 v139, v86, v87
    v_pk_mul_f32 v[88:89], v[88:89], v[242:243] op_sel_hi:[1,0]
    v_pk_mul_f32 v[90:91], v[90:91], v[242:243] op_sel_hi:[1,0]
    v_pk_mul_f32 v[92:93], v[92:93], v[242:243] op_sel_hi:[1,0]
    v_pk_mul_f32 v[94:95], v[94:95], v[242:243] op_sel_hi:[1,0]
    s_add_u32 s64, s80, 1024
    buffer_load_dwordx4 a[40:43], v4, s[40:43], s64 offen sc1
    v_pk_mul_f32 v[200:201], v[88:89], v[88:89]
    v_pk_mul_f32 v[202:203], v[90:91], v[90:91]
    v_pk_mul_f32 v[204:205], v[92:93], v[92:93]
    v_pk_mul_f32 v[206:207], v[94:95], v[94:95]
    s_add_u32 s64, s81, 1024
    buffer_load_dwordx4 a[44:47], v4, s[40:43], s64 offen sc1
    v_pk_fma_f32 v[200:201], v[200:201], s[74:75], v[28:29]
    v_pk_fma_f32 v[202:203], v[202:203], s[74:75], v[28:29]
    v_pk_fma_f32 v[204:205], v[204:205], s[74:75], v[28:29]
    v_pk_fma_f32 v[206:207], v[206:207], s[74:75], v[28:29]
    s_add_u32 s64, s80, 2048
    buffer_load_dwordx4 a[48:51], v4, s[40:43], s64 offen sc1
    v_pk_mul_f32 v[200:201], v[200:201], v[88:89]
    v_pk_mul_f32 v[202:203], v[202:203], v[90:91]
    v_pk_mul_f32 v[204:205], v[204:205], v[92:93]
    v_pk_mul_f32 v[206:207], v[206:207], v[94:95]
    v_exp_f32 v200, v200
    v_exp_f32 v201, v201
    v_exp_f32 v202, v202
    v_exp_f32 v203, v203
    v_exp_f32 v204, v204
    v_exp_f32 v205, v205
    v_exp_f32 v206, v206
    v_exp_f32 v207, v207
    v_pk_add_f32 v[200:201], v[200:201], 1.0 op_sel_hi:[1,0]
    v_pk_add_f32 v[202:203], v[202:203], 1.0 op_sel_hi:[1,0]
    v_pk_add_f32 v[204:205], v[204:205], 1.0 op_sel_hi:[1,0]
    v_pk_add_f32 v[206:207], v[206:207], 1.0 op_sel_hi:[1,0]
    v_rcp_f32 v200, v200
    v_rcp_f32 v201, v201
    v_rcp_f32 v202, v202
    v_rcp_f32 v203, v203
    v_rcp_f32 v204, v204
    v_rcp_f32 v205, v205
    v_rcp_f32 v206, v206
    v_rcp_f32 v207, v207
    v_pk_mul_f32 v[88:89], v[88:89], v[200:201]
    v_pk_mul_f32 v[90:91], v[90:91], v[202:203]
    v_pk_mul_f32 v[92:93], v[92:93], v[204:205]
    v_pk_mul_f32 v[94:95], v[94:95], v[206:207]
    v_cvt_pk_bf16_f32 v140, v88, v89
    v_cvt_pk_bf16_f32 v141, v90, v91
    v_cvt_pk_bf16_f32 v142, v92, v93
    v_cvt_pk_bf16_f32 v143, v94, v95
    buffer_store_dwordx4 v[136:139], v4, s[40:43], s71 offen offset:2048 sc1
    buffer_store_dwordx4 v[140:143], v4, s[40:43], s71 offen offset:3072 sc1
    ds_read_b64_tr_b16 a[168:169], v38 offset:10240
    ds_read_b64_tr_b16 a[170:171], v38 offset:11264
    ds_read_b64_tr_b16 a[172:173], v39 offset:10240
    ds_read_b64_tr_b16 a[174:175], v39 offset:11264
    ds_read_b64_tr_b16 a[176:177], v38 offset:12288
    ds_read_b64_tr_b16 a[178:179], v38 offset:13312
    ds_read_b64_tr_b16 a[180:181], v39 offset:12288
    ds_read_b64_tr_b16 a[182:183], v39 offset:13312
    ds_read_b64_tr_b16 a[184:185], v38 offset:14336
    ds_read_b64_tr_b16 a[186:187], v38 offset:15360
    v_pk_mul_f32 v[96:97], v[96:97], v[242:243] op_sel_hi:[1,0]
    v_pk_mul_f32 v[98:99], v[98:99], v[242:243] op_sel_hi:[1,0]
    v_pk_mul_f32 v[100:101], v[100:101], v[242:243] op_sel_hi:[1,0]
    v_pk_mul_f32 v[102:103], v[102:103], v[242:243] op_sel_hi:[1,0]
    s_add_u32 s64, s81, 2048
    buffer_load_dwordx4 a[52:55], v4, s[40:43], s64 offen sc1
    v_pk_mul_f32 v[192:193], v[96:97], v[96:97]
    v_pk_mul_f32 v[194:195], v[98:99], v[98:99]
    v_pk_mul_f32 v[196:197], v[100:101], v[100:101]
    v_pk_mul_f32 v[198:199], v[102:103], v[102:103]
    s_add_u32 s64, s80, 3072
    buffer_load_dwordx4 a[56:59], v4, s[40:43], s64 offen sc1
    v_pk_fma_f32 v[192:193], v[192:193], s[74:75], v[28:29]
    v_pk_fma_f32 v[194:195], v[194:195], s[74:75], v[28:29]
    v_pk_fma_f32 v[196:197], v[196:197], s[74:75], v[28:29]
    v_pk_fma_f32 v[198:199], v[198:199], s[74:75], v[28:29]
    s_add_u32 s64, s81, 3072
    buffer_load_dwordx4 a[60:63], v4, s[40:43], s64 offen sc1
    v_pk_mul_f32 v[192:193], v[192:193], v[96:97]
    v_pk_mul_f32 v[194:195], v[194:195], v[98:99]
    v_pk_mul_f32 v[196:197], v[196:197], v[100:101]
    v_pk_mul_f32 v[198:199], v[198:199], v[102:103]
    s_lshl_b32 s64, s48, 14
    s_add_u32 m0, s64, 77824
    s_mul_i32 s64, s48, 131072
    s_lshl_b32 s61, s50, 7
    s_add_u32 s64, s64, s61
    s_add_u32 s64, s64, 65536
    buffer_load_dwordx4 v10, s[12:15], s64 offen lds
    v_exp_f32 v192, v192
    v_exp_f32 v193, v193
    v_exp_f32 v194, v194
    v_exp_f32 v195, v195
    v_exp_f32 v196, v196
    v_exp_f32 v197, v197
    v_exp_f32 v198, v198
    v_exp_f32 v199, v199
    v_pk_add_f32 v[192:193], v[192:193], 1.0 op_sel_hi:[1,0]
    v_pk_add_f32 v[194:195], v[194:195], 1.0 op_sel_hi:[1,0]
    v_pk_add_f32 v[196:197], v[196:197], 1.0 op_sel_hi:[1,0]
    v_pk_add_f32 v[198:199], v[198:199], 1.0 op_sel_hi:[1,0]
    v_rcp_f32 v192, v192
    v_rcp_f32 v193, v193
    v_rcp_f32 v194, v194
    v_rcp_f32 v195, v195
    v_rcp_f32 v196, v196
    v_rcp_f32 v197, v197
    v_rcp_f32 v198, v198
    v_rcp_f32 v199, v199
    v_pk_mul_f32 v[96:97], v[96:97], v[192:193]
    v_pk_mul_f32 v[98:99], v[98:99], v[194:195]
    v_pk_mul_f32 v[100:101], v[100:101], v[196:197]
    v_pk_mul_f32 v[102:103], v[102:103], v[198:199]
    v_cvt_pk_bf16_f32 v144, v96, v97
    v_cvt_pk_bf16_f32 v145, v98, v99
    v_cvt_pk_bf16_f32 v146, v100, v101
    v_cvt_pk_bf16_f32 v147, v102, v103
    v_pk_mul_f32 v[104:105], v[104:105], v[242:243] op_sel_hi:[1,0]
    v_pk_mul_f32 v[106:107], v[106:107], v[242:243] op_sel_hi:[1,0]
    v_pk_mul_f32 v[108:109], v[108:109], v[242:243] op_sel_hi:[1,0]
    v_pk_mul_f32 v[110:111], v[110:111], v[242:243] op_sel_hi:[1,0]
    buffer_load_dwordx4 v11, s[12:15], s64 offen offset:1024 lds
    v_pk_mul_f32 v[200:201], v[104:105], v[104:105]
    v_pk_mul_f32 v[202:203], v[106:107], v[106:107]
    v_pk_mul_f32 v[204:205], v[108:109], v[108:109]
    v_pk_mul_f32 v[206:207], v[110:111], v[110:111]
    buffer_load_dwordx4 v12, s[12:15], s64 offen offset:2048 lds
    v_pk_fma_f32 v[200:201], v[200:201], s[74:75], v[28:29]
    v_pk_fma_f32 v[202:203], v[202:203], s[74:75], v[28:29]
    v_pk_fma_f32 v[204:205], v[204:205], s[74:75], v[28:29]
    v_pk_fma_f32 v[206:207], v[206:207], s[74:75], v[28:29]
    buffer_load_dwordx4 v13, s[12:15], s64 offen offset:3072 lds
    v_pk_mul_f32 v[200:201], v[200:201], v[104:105]
    v_pk_mul_f32 v[202:203], v[202:203], v[106:107]
    v_pk_mul_f32 v[204:205], v[204:205], v[108:109]
    v_pk_mul_f32 v[206:207], v[206:207], v[110:111]
    v_exp_f32 v200, v200
    v_exp_f32 v201, v201
    v_exp_f32 v202, v202
    v_exp_f32 v203, v203
    v_exp_f32 v204, v204
    v_exp_f32 v205, v205
    v_exp_f32 v206, v206
    v_exp_f32 v207, v207
    v_pk_add_f32 v[200:201], v[200:201], 1.0 op_sel_hi:[1,0]
    v_pk_add_f32 v[202:203], v[202:203], 1.0 op_sel_hi:[1,0]
    v_pk_add_f32 v[204:205], v[204:205], 1.0 op_sel_hi:[1,0]
    v_pk_add_f32 v[206:207], v[206:207], 1.0 op_sel_hi:[1,0]
    v_rcp_f32 v200, v200
    v_rcp_f32 v201, v201
    v_rcp_f32 v202, v202
    v_rcp_f32 v203, v203
    v_rcp_f32 v204, v204
    v_rcp_f32 v205, v205
    v_rcp_f32 v206, v206
    v_rcp_f32 v207, v207
    v_pk_mul_f32 v[104:105], v[104:105], v[200:201]
    v_pk_mul_f32 v[106:107], v[106:107], v[202:203]
    v_pk_mul_f32 v[108:109], v[108:109], v[204:205]
    v_pk_mul_f32 v[110:111], v[110:111], v[206:207]
    v_cvt_pk_bf16_f32 v148, v104, v105
    v_cvt_pk_bf16_f32 v149, v106, v107
    v_cvt_pk_bf16_f32 v150, v108, v109
    v_cvt_pk_bf16_f32 v151, v110, v111
    buffer_store_dwordx4 v[144:147], v4, s[40:43], s84 offen offset:0 sc1
    buffer_store_dwordx4 v[148:151], v4, s[40:43], s84 offen offset:1024 sc1
    ds_read_b64_tr_b16 a[188:189], v39 offset:14336
    ds_read_b64_tr_b16 a[190:191], v39 offset:15360
    ds_read_b64_tr_b16 a[192:193], v42 offset:0
    ds_read_b64_tr_b16 a[194:195], v42 offset:1024
    ds_read_b64_tr_b16 a[196:197], v43 offset:0
    ds_read_b64_tr_b16 a[198:199], v43 offset:1024
    ds_read_b64_tr_b16 a[200:201], v42 offset:2048
    ds_read_b64_tr_b16 a[202:203], v42 offset:3072
    ds_read_b64_tr_b16 a[204:205], v43 offset:2048
    ds_read_b64_tr_b16 a[206:207], v43 offset:3072
    v_pk_mul_f32 v[112:113], v[112:113], v[242:243] op_sel_hi:[1,0]
    v_pk_mul_f32 v[114:115], v[114:115], v[242:243] op_sel_hi:[1,0]
    v_pk_mul_f32 v[116:117], v[116:117], v[242:243] op_sel_hi:[1,0]
    v_pk_mul_f32 v[118:119], v[118:119], v[242:243] op_sel_hi:[1,0]
    s_lshl_b32 s64, s48, 14
    s_add_u32 m0, s64, 81920
    s_mul_i32 s64, s48, 131072
    s_lshl_b32 s61, s50, 7
    s_add_u32 s64, s64, s61
    s_add_u32 s64, s64, 98304
    buffer_load_dwordx4 v10, s[12:15], s64 offen lds
    v_pk_mul_f32 v[192:193], v[112:113], v[112:113]
    v_pk_mul_f32 v[194:195], v[114:115], v[114:115]
    v_pk_mul_f32 v[196:197], v[116:117], v[116:117]
    v_pk_mul_f32 v[198:199], v[118:119], v[118:119]
    buffer_load_dwordx4 v11, s[12:15], s64 offen offset:1024 lds
    v_pk_fma_f32 v[192:193], v[192:193], s[74:75], v[28:29]
    v_pk_fma_f32 v[194:195], v[194:195], s[74:75], v[28:29]
    v_pk_fma_f32 v[196:197], v[196:197], s[74:75], v[28:29]
    v_pk_fma_f32 v[198:199], v[198:199], s[74:75], v[28:29]
    buffer_load_dwordx4 v12, s[12:15], s64 offen offset:2048 lds
    v_pk_mul_f32 v[192:193], v[192:193], v[112:113]
    v_pk_mul_f32 v[194:195], v[194:195], v[114:115]
    v_pk_mul_f32 v[196:197], v[196:197], v[116:117]
    v_pk_mul_f32 v[198:199], v[198:199], v[118:119]
    buffer_load_dwordx4 v13, s[12:15], s64 offen offset:3072 lds
    v_exp_f32 v192, v192
    v_exp_f32 v193, v193
    v_exp_f32 v194, v194
    v_exp_f32 v195, v195
    v_exp_f32 v196, v196
    v_exp_f32 v197, v197
    v_exp_f32 v198, v198
    v_exp_f32 v199, v199
    v_pk_add_f32 v[192:193], v[192:193], 1.0 op_sel_hi:[1,0]
    v_pk_add_f32 v[194:195], v[194:195], 1.0 op_sel_hi:[1,0]
    v_pk_add_f32 v[196:197], v[196:197], 1.0 op_sel_hi:[1,0]
    v_pk_add_f32 v[198:199], v[198:199], 1.0 op_sel_hi:[1,0]
    v_rcp_f32 v192, v192
    v_rcp_f32 v193, v193
    v_rcp_f32 v194, v194
    v_rcp_f32 v195, v195
    v_rcp_f32 v196, v196
    v_rcp_f32 v197, v197
    v_rcp_f32 v198, v198
    v_rcp_f32 v199, v199
    v_pk_mul_f32 v[112:113], v[112:113], v[192:193]
    v_pk_mul_f32 v[114:115], v[114:115], v[194:195]
    v_pk_mul_f32 v[116:117], v[116:117], v[196:197]
    v_pk_mul_f32 v[118:119], v[118:119], v[198:199]
    v_cvt_pk_bf16_f32 v152, v112, v113
    v_cvt_pk_bf16_f32 v153, v114, v115
    v_cvt_pk_bf16_f32 v154, v116, v117
    v_cvt_pk_bf16_f32 v155, v118, v119
    v_pk_mul_f32 v[120:121], v[120:121], v[242:243] op_sel_hi:[1,0]
    v_pk_mul_f32 v[122:123], v[122:123], v[242:243] op_sel_hi:[1,0]
    v_pk_mul_f32 v[124:125], v[124:125], v[242:243] op_sel_hi:[1,0]
    v_pk_mul_f32 v[126:127], v[126:127], v[242:243] op_sel_hi:[1,0]
    v_pk_mul_f32 v[200:201], v[120:121], v[120:121]
    v_pk_mul_f32 v[202:203], v[122:123], v[122:123]
    v_pk_mul_f32 v[204:205], v[124:125], v[124:125]
    v_pk_mul_f32 v[206:207], v[126:127], v[126:127]
    v_pk_fma_f32 v[200:201], v[200:201], s[74:75], v[28:29]
    v_pk_fma_f32 v[202:203], v[202:203], s[74:75], v[28:29]
    v_pk_fma_f32 v[204:205], v[204:205], s[74:75], v[28:29]
    v_pk_fma_f32 v[206:207], v[206:207], s[74:75], v[28:29]
    v_pk_mul_f32 v[200:201], v[200:201], v[120:121]
    v_pk_mul_f32 v[202:203], v[202:203], v[122:123]
    v_pk_mul_f32 v[204:205], v[204:205], v[124:125]
    v_pk_mul_f32 v[206:207], v[206:207], v[126:127]
    v_exp_f32 v200, v200
    v_exp_f32 v201, v201
    v_exp_f32 v202, v202
    v_exp_f32 v203, v203
    v_exp_f32 v204, v204
    v_exp_f32 v205, v205
    v_exp_f32 v206, v206
    v_exp_f32 v207, v207
    v_pk_add_f32 v[200:201], v[200:201], 1.0 op_sel_hi:[1,0]
    v_pk_add_f32 v[202:203], v[202:203], 1.0 op_sel_hi:[1,0]
    v_pk_add_f32 v[204:205], v[204:205], 1.0 op_sel_hi:[1,0]
    v_pk_add_f32 v[206:207], v[206:207], 1.0 op_sel_hi:[1,0]
    v_rcp_f32 v200, v200
    v_rcp_f32 v201, v201
    v_rcp_f32 v202, v202
    v_rcp_f32 v203, v203
    v_rcp_f32 v204, v204
    v_rcp_f32 v205, v205
    v_rcp_f32 v206, v206
    v_rcp_f32 v207, v207
    v_pk_mul_f32 v[120:121], v[120:121], v[200:201]
    v_pk_mul_f32 v[122:123], v[122:123], v[202:203]
    v_pk_mul_f32 v[124:125], v[124:125], v[204:205]
    v_pk_mul_f32 v[126:127], v[126:127], v[206:207]
    v_cvt_pk_bf16_f32 v156, v120, v121
    v_cvt_pk_bf16_f32 v157, v122, v123
    v_cvt_pk_bf16_f32 v158, v124, v125
    v_cvt_pk_bf16_f32 v159, v126, v127
    buffer_store_dwordx4 v[152:155], v4, s[40:43], s84 offen offset:2048 sc1
    buffer_store_dwordx4 v[156:159], v4, s[40:43], s84 offen offset:3072 sc1
    s_waitcnt lgkmcnt(0)
    s_mov_b32 s64, 24576
    v_lshlrev_b32 v63, 2, v1
    buffer_load_dword v63, v63, s[40:43], s64 offen sc1
    s_waitcnt vmcnt(1)
    s_barrier
    s_cmp_lg_u32 s48, 0
    s_cbranch_scc1 Lp326
    s_lshl_b32 s58, s51, 7
    s_lshl_b32 s59, s52, 2
    s_add_u32 s58, s58, s59
    s_add_u32 s58, s58, 16384
    s_cmp_eq_u32 s54, 0
    s_cbranch_scc1 Lp327
    v_mov_b32 v54, s53
    v_mov_b32 v55, 0
    v_cmp_eq_u32 vcc, 0, v1
    s_nop 1
    s_and_saveexec_b64 s[62:63], vcc
    buffer_store_dword v54, v55, s[40:43], s58 offen
    s_mov_b64 exec, s[62:63]
    s_branch Lp328
Lp327:
    v_mov_b32 v54, s53
    v_mov_b32 v55, 0
    v_cmp_eq_u32 vcc, 0, v1
    s_nop 1
    s_and_saveexec_b64 s[62:63], vcc
    buffer_store_dword v54, v55, s[40:43], s58 offen sc1
    s_mov_b64 exec, s[62:63]
Lp328:
Lp326:
    s_waitcnt vmcnt(0)
    s_mov_b32 s93, 0x40000
    s_mov_b32 s58, 24576
    v_lshlrev_b32 v55, 2, v1
    v_cmp_gt_u32 vcc, 32, v1
    s_nop 1
    s_and_saveexec_b64 s[62:63], vcc
    s_nop 1
Lfc29:
    v_cmp_ne_u32 vcc, s53, v63
    s_nop 4
    s_cbranch_vccz Lfco30
    s_sub_u32 s93, s93, 1
    s_cmp_eq_u32 s93, 0
    s_cbranch_scc1 Lfco30
    buffer_load_dword v63, v55, s[40:43], s58 offen sc1
    s_waitcnt vmcnt(0)
    s_branch Lfc29
Lfco30:
    s_mov_b64 exec, s[62:63]
    s_branch LJ23
LA222:
    s_lshl_b32 s95, s51, 1
    s_add_u32 s95, s95, s52
    s_sub_u32 s95, s95, 14
    s_cmp_lg_u32 s48, 0
    s_cbranch_scc1 Lpolls33
    s_lshr_b32 s58, s95, 2
    s_lshl_b32 s58, s58, 7
    s_add_u32 s58, s58, 20480
    v_lshlrev_b32 v55, 2, v1
    v_cmp_gt_u32 vcc, 32, v1
    s_nop 1
    s_and_saveexec_b64 s[62:63], vcc
    s_mov_b32 s93, 0x40000
    s_nop 0
Lpoll31:
    s_sub_u32 s93, s93, 1
    s_cmp_eq_u32 s93, 0
    s_cbranch_scc1 Lpollx32
    buffer_load_dword v54, v55, s[40:43], s58 offen sc1
    s_waitcnt vmcnt(0)
    v_cmp_ne_u32 vcc, s53, v54
    s_nop 4
    s_cbranch_vccnz Lpoll31
Lpollx32:
    s_mov_b64 exec, s[62:63]
Lpolls33:
    s_barrier
    v_and_b32 v55, 15, v2
    v_mov_b32 v56, 16
    v_and_b32 v57, 16, v1
    s_and_b32 s58, s95, 1
    s_lshl_b32 s58, s58, 4
    v_cmp_ne_u32 vcc, s58, v57
    s_nop 1
    v_cndmask_b32 v58, v55, v56, vcc
    v_mul_u32_u24 v57, 544, v3
    v_lshlrev_b32 v58, 5, v58
    v_add_u32 v58, v58, v57
    s_lshr_b32 s58, s95, 2
    s_lshl_b32 s59, s48, 6
    s_add_u32 s58, s58, s59
    s_mul_i32 s58, s58, 4352
    s_and_b32 s59, s95, 3
    s_mul_i32 s59, s59, 1088
    s_add_u32 s58, s58, s59
    s_add_u32 s71, s58, 8388608
    buffer_load_dwordx4 v[64:67], v58, s[40:43], s71 offen offset:0 sc1
    buffer_load_dwordx4 v[68:71], v58, s[40:43], s71 offen offset:16 sc1
    s_add_u32 s71, s71, 34816
    buffer_load_dwordx4 v[72:75], v58, s[40:43], s71 offen offset:0 sc1
    buffer_load_dwordx4 v[76:79], v58, s[40:43], s71 offen offset:16 sc1
    s_add_u32 s71, s71, 34816
    buffer_load_dwordx4 v[80:83], v58, s[40:43], s71 offen offset:0 sc1
    buffer_load_dwordx4 v[84:87], v58, s[40:43], s71 offen offset:16 sc1
    s_add_u32 s71, s71, 34816
    buffer_load_dwordx4 v[88:91], v58, s[40:43], s71 offen offset:0 sc1
    buffer_load_dwordx4 v[92:95], v58, s[40:43], s71 offen offset:16 sc1
    s_add_u32 s71, s71, 34816
    buffer_load_dwordx4 v[96:99], v58, s[40:43], s71 offen offset:0 sc1
    buffer_load_dwordx4 v[100:103], v58, s[40:43], s71 offen offset:16 sc1
    s_add_u32 s71, s71, 34816
    buffer_load_dwordx4 v[104:107], v58, s[40:43], s71 offen offset:0 sc1
    buffer_load_dwordx4 v[108:111], v58, s[40:43], s71 offen offset:16 sc1
    s_add_u32 s71, s71, 34816
    buffer_load_dwordx4 v[112:115], v58, s[40:43], s71 offen offset:0 sc1
    buffer_load_dwordx4 v[116:119], v58, s[40:43], s71 offen offset:16 sc1
    s_add_u32 s71, s71, 34816
    buffer_load_dwordx4 v[120:123], v58, s[40:43], s71 offen offset:0 sc1
    buffer_load_dwordx4 v[124:127], v58, s[40:43], s71 offen offset:16 sc1
    s_waitcnt vmcnt(12)
    v_pk_add_f32 v[64:65], v[64:65], v[72:73]
    v_pk_add_f32 v[66:67], v[66:67], v[74:75]
    v_pk_add_f32 v[68:69], v[68:69], v[76:77]
    v_pk_add_f32 v[70:71], v[70:71], v[78:79]
    s_waitcnt vmcnt(10)
    v_pk_add_f32 v[64:65], v[64:65], v[80:81]
    v_pk_add_f32 v[66:67], v[66:67], v[82:83]
    v_pk_add_f32 v[68:69], v[68:69], v[84:85]
    v_pk_add_f32 v[70:71], v[70:71], v[86:87]
    s_waitcnt vmcnt(8)
    v_pk_add_f32 v[64:65], v[64:65], v[88:89]
    v_pk_add_f32 v[66:67], v[66:67], v[90:91]
    v_pk_add_f32 v[68:69], v[68:69], v[92:93]
    v_pk_add_f32 v[70:71], v[70:71], v[94:95]
    s_waitcnt vmcnt(6)
    v_pk_add_f32 v[64:65], v[64:65], v[96:97]
    v_pk_add_f32 v[66:67], v[66:67], v[98:99]
    v_pk_add_f32 v[68:69], v[68:69], v[100:101]
    v_pk_add_f32 v[70:71], v[70:71], v[102:103]
    s_waitcnt vmcnt(4)
    v_pk_add_f32 v[64:65], v[64:65], v[104:105]
    v_pk_add_f32 v[66:67], v[66:67], v[106:107]
    v_pk_add_f32 v[68:69], v[68:69], v[108:109]
    v_pk_add_f32 v[70:71], v[70:71], v[110:111]
    s_waitcnt vmcnt(2)
    v_pk_add_f32 v[64:65], v[64:65], v[112:113]
    v_pk_add_f32 v[66:67], v[66:67], v[114:115]
    v_pk_add_f32 v[68:69], v[68:69], v[116:117]
    v_pk_add_f32 v[70:71], v[70:71], v[118:119]
    s_waitcnt vmcnt(0)
    v_pk_add_f32 v[64:65], v[64:65], v[120:121]
    v_pk_add_f32 v[66:67], v[66:67], v[122:123]
    v_pk_add_f32 v[68:69], v[68:69], v[124:125]
    v_pk_add_f32 v[70:71], v[70:71], v[126:127]
    s_lshl_b32 s58, s48, 11
    s_add_u32 s58, s58, 118784
    v_add_u32 v54, s58, v4
    ds_write_b128 v54, v[64:67]
    ds_write_b128 v54, v[68:71] offset:1024
    s_waitcnt lgkmcnt(0)
    s_barrier
    s_cmp_lg_u32 s48, 0
    s_cbranch_scc1 La234
    v_add_u32 v54, 118784, v4
    ds_read_b128 v[72:75], v54 offset:2048
    ds_read_b128 v[76:79], v54 offset:3072
    ds_read_b128 v[80:83], v54 offset:4096
    ds_read_b128 v[84:87], v54 offset:5120
    ds_read_b128 v[88:91], v54 offset:6144
    ds_read_b128 v[92:95], v54 offset:7168
    s_waitcnt lgkmcnt(0)
    v_pk_add_f32 v[64:65], v[64:65], v[72:73]
    v_pk_add_f32 v[66:67], v[66:67], v[74:75]
    v_pk_add_f32 v[68:69], v[68:69], v[76:77]
    v_pk_add_f32 v[70:71], v[70:71], v[78:79]
    v_pk_add_f32 v[64:65], v[64:65], v[80:81]
    v_pk_add_f32 v[66:67], v[66:67], v[82:83]
    v_pk_add_f32 v[68:69], v[68:69], v[84:85]
    v_pk_add_f32 v[70:71], v[70:71], v[86:87]
    v_pk_add_f32 v[64:65], v[64:65], v[88:89]
    v_pk_add_f32 v[66:67], v[66:67], v[90:91]
    v_pk_add_f32 v[68:69], v[68:69], v[92:93]
    v_pk_add_f32 v[70:71], v[70:71], v[94:95]
    v_cvt_pk_bf16_f32 v96, v64, v65
    v_cvt_pk_bf16_f32 v97, v66, v67
    v_cvt_pk_bf16_f32 v98, v68, v69
    v_cvt_pk_bf16_f32 v99, v70, v71
    s_lshl_b32 s58, s95, 10
    s_add_u32 s71, s58, 7864320
    buffer_store_dwordx4 v[96:99], v4, s[40:43], s71 offen sc1
    s_waitcnt vmcnt(0)
    s_lshl_b32 s58, s95, 2
    s_add_u32 s58, s58, 24576
    v_mov_b32 v54, s53
    v_mov_b32 v55, 0
    v_cmp_eq_u32 vcc, 0, v1
    s_nop 1
    s_and_saveexec_b64 s[62:63], vcc
    buffer_store_dword v54, v55, s[40:43], s58 offen sc1
    s_mov_b64 exec, s[62:63]
La234:
    s_barrier
    s_lshl_b32 s64, s67, 2
    s_add_u32 s64, s64, s48
    s_lshl_b32 s64, s64, 11
    s_add_u32 s64, s64, 262144
    s_mov_b64 exec, 0xffff
    buffer_load_dword v27, v5, s[32:35], s64 offen
    s_mov_b64 exec, -1
    s_lshl_b32 s64, s67, 2
    s_add_u32 s64, s64, s48
    s_lshl_b32 s64, s64, 11
    s_add_u32 s64, s64, 524288
    s_mov_b64 exec, 0xffff
    buffer_load_dword v27, v5, s[32:35], s64 offen
    s_mov_b64 exec, -1
    s_lshl_b32 s64, s67, 2
    s_add_u32 s64, s64, s48
    s_lshl_b32 s64, s64, 11
    s_add_u32 s64, s64, 786432
    s_mov_b64 exec, 0xffff
    buffer_load_dword v27, v5, s[32:35], s64 offen
    s_mov_b64 exec, -1
    s_lshl_b32 s64, s67, 2
    s_add_u32 s64, s64, s48
    s_lshl_b32 s64, s64, 11
    s_add_u32 s64, s64, 1048576
    s_mov_b64 exec, 0xffff
    buffer_load_dword v27, v5, s[32:35], s64 offen
    s_mov_b64 exec, -1
    s_lshl_b32 s64, s67, 2
    s_add_u32 s64, s64, s48
    s_lshl_b32 s64, s64, 11
    s_add_u32 s64, s64, 1310720
    s_mov_b64 exec, 0xffff
    buffer_load_dword v27, v5, s[32:35], s64 offen
    s_mov_b64 exec, -1
    s_lshl_b32 s64, s67, 2
    s_add_u32 s64, s64, s48
    s_lshl_b32 s64, s64, 11
    s_add_u32 s64, s64, 1572864
    s_mov_b64 exec, 0xffff
    buffer_load_dword v27, v5, s[32:35], s64 offen
    s_mov_b64 exec, -1
    s_cmp_eq_u32 s91, 0
    s_cselect_b64 vcc, -1, 0
    v_cndmask_b32 v42, v9, v8, vcc
    v_cndmask_b32 v43, v8, v9, vcc
    s_lshl_b32 s58, s48, 14
    v_add_u32 v38, s58, v42
    v_add_u32 v39, s58, v43
    v_add_u32 v40, 69632, v38
    v_add_u32 v41, 69632, v39
    s_lshl_b32 s58, s48, 12
    s_add_u32 s58, s58, 135168
    v_add_u32 v42, s58, v42
    v_add_u32 v43, s58, v43
    s_lshl_b32 s64, s48, 14
    s_add_u32 m0, s64, 0
    s_lshl_b32 s64, s48, 15
    s_lshl_b32 s61, s50, 7
    s_add_u32 s64, s64, s61
    s_add_u32 s64, s64, 0
    buffer_load_dwordx4 v10, s[32:35], s64 offen lds
    buffer_load_dwordx4 v11, s[32:35], s64 offen offset:1024 lds
    buffer_load_dwordx4 v12, s[32:35], s64 offen offset:2048 lds
    buffer_load_dwordx4 v13, s[32:35], s64 offen offset:3072 lds
    s_lshl_b32 s64, s48, 14
    s_add_u32 m0, s64, 4096
    s_lshl_b32 s64, s48, 15
    s_lshl_b32 s61, s50, 7
    s_add_u32 s64, s64, s61
    s_add_u32 s64, s64, 131072
    buffer_load_dwordx4 v10, s[32:35], s64 offen lds
    buffer_load_dwordx4 v11, s[32:35], s64 offen offset:1024 lds
    buffer_load_dwordx4 v12, s[32:35], s64 offen offset:2048 lds
    buffer_load_dwordx4 v13, s[32:35], s64 offen offset:3072 lds
    s_lshl_b32 s64, s48, 14
    s_add_u32 m0, s64, 8192
    s_lshl_b32 s64, s48, 15
    s_lshl_b32 s61, s50, 7
    s_add_u32 s64, s64, s61
    s_add_u32 s64, s64, 262144
    buffer_load_dwordx4 v10, s[32:35], s64 offen lds
    buffer_load_dwordx4 v11, s[32:35], s64 offen offset:1024 lds
    buffer_load_dwordx4 v12, s[32:35], s64 offen offset:2048 lds
    buffer_load_dwordx4 v13, s[32:35], s64 offen offset:3072 lds
    s_lshl_b32 s64, s48, 14
    s_add_u32 m0, s64, 12288
    s_lshl_b32 s64, s48, 15
    s_lshl_b32 s61, s50, 7
    s_add_u32 s64, s64, s61
    s_add_u32 s64, s64, 393216
    buffer_load_dwordx4 v10, s[32:35], s64 offen lds
    buffer_load_dwordx4 v11, s[32:35], s64 offen offset:1024 lds
    buffer_load_dwordx4 v12, s[32:35], s64 offen offset:2048 lds
    buffer_load_dwordx4 v13, s[32:35], s64 offen offset:3072 lds
    s_lshl_b32 s64, s48, 12
    s_add_u32 m0, s64, 135168
    s_lshl_b32 s64, s48, 15
    s_lshl_b32 s61, s50, 7
    s_add_u32 s64, s64, s61
    s_add_u32 s64, s64, 524288
    buffer_load_dwordx4 v10, s[32:35], s64 offen lds
    buffer_load_dwordx4 v11, s[32:35], s64 offen offset:1024 lds
    buffer_load_dwordx4 v12, s[32:35], s64 offen offset:2048 lds
    buffer_load_dwordx4 v13, s[32:35], s64 offen offset:3072 lds
    s_lshl_b32 s64, s48, 14
    s_add_u32 m0, s64, 69632
    s_mul_i32 s64, s48, 131072
    s_lshl_b32 s61, s50, 7
    s_add_u32 s64, s64, s61
    s_add_u32 s64, s64, 0
    buffer_load_dwordx4 v10, s[12:15], s64 offen lds
    buffer_load_dwordx4 v11, s[12:15], s64 offen offset:1024 lds
    buffer_load_dwordx4 v12, s[12:15], s64 offen offset:2048 lds
    buffer_load_dwordx4 v13, s[12:15], s64 offen offset:3072 lds
    s_lshl_b32 s64, s48, 14
    s_add_u32 m0, s64, 73728
    s_mul_i32 s64, s48, 131072
    s_lshl_b32 s61, s50, 7
    s_add_u32 s64, s64, s61
    s_add_u32 s64, s64, 32768
    buffer_load_dwordx4 v10, s[12:15], s64 offen lds
    buffer_load_dwordx4 v11, s[12:15], s64 offen offset:1024 lds
    buffer_load_dwordx4 v12, s[12:15], s64 offen offset:2048 lds
    buffer_load_dwordx4 v13, s[12:15], s64 offen offset:3072 lds
    s_lshl_b32 s64, s48, 14
    s_add_u32 m0, s64, 77824
    s_mul_i32 s64, s48, 131072
    s_lshl_b32 s61, s50, 7
    s_add_u32 s64, s64, s61
    s_add_u32 s64, s64, 65536
    buffer_load_dwordx4 v10, s[12:15], s64 offen lds
    buffer_load_dwordx4 v11, s[12:15], s64 offen offset:1024 lds
    buffer_load_dwordx4 v12, s[12:15], s64 offen offset:2048 lds
    buffer_load_dwordx4 v13, s[12:15], s64 offen offset:3072 lds
    s_lshl_b32 s64, s48, 14
    s_add_u32 m0, s64, 81920
    s_mul_i32 s64, s48, 131072
    s_lshl_b32 s61, s50, 7
    s_add_u32 s64, s64, s61
    s_add_u32 s64, s64, 98304
    buffer_load_dwordx4 v10, s[12:15], s64 offen lds
    buffer_load_dwordx4 v11, s[12:15], s64 offen offset:1024 lds
    buffer_load_dwordx4 v12, s[12:15], s64 offen offset:2048 lds
    buffer_load_dwordx4 v13, s[12:15], s64 offen offset:3072 lds
    s_waitcnt vmcnt(0)
    ds_read_b64_tr_b16 a[128:129], v38 offset:0
    ds_read_b64_tr_b16 a[130:131], v38 offset:1024
    ds_read_b64_tr_b16 a[132:133], v39 offset:0
    ds_read_b64_tr_b16 a[134:135], v39 offset:1024
    ds_read_b64_tr_b16 a[136:137], v38 offset:2048
    ds_read_b64_tr_b16 a[138:139], v38 offset:3072
    ds_read_b64_tr_b16 a[140:141], v39 offset:2048
    ds_read_b64_tr_b16 a[142:143], v39 offset:3072
    ds_read_b64_tr_b16 a[144:145], v38 offset:4096
    ds_read_b64_tr_b16 a[146:147], v38 offset:5120
    ds_read_b64_tr_b16 a[148:149], v39 offset:4096
    ds_read_b64_tr_b16 a[150:151], v39 offset:5120
    ds_read_b64_tr_b16 a[152:153], v38 offset:6144
    ds_read_b64_tr_b16 a[154:155], v38 offset:7168
    ds_read_b64_tr_b16 a[156:157], v39 offset:6144
    ds_read_b64_tr_b16 a[158:159], v39 offset:7168
    ds_read_b64_tr_b16 a[160:161], v38 offset:8192
    ds_read_b64_tr_b16 a[162:163], v38 offset:9216
    ds_read_b64_tr_b16 a[164:165], v39 offset:8192
    ds_read_b64_tr_b16 a[166:167], v39 offset:9216
    ds_read_b64_tr_b16 a[168:169], v38 offset:10240
    ds_read_b64_tr_b16 a[170:171], v38 offset:11264
    ds_read_b64_tr_b16 a[172:173], v39 offset:10240
    ds_read_b64_tr_b16 a[174:175], v39 offset:11264
    ds_read_b64_tr_b16 a[176:177], v38 offset:12288
    ds_read_b64_tr_b16 a[178:179], v38 offset:13312
    ds_read_b64_tr_b16 a[180:181], v39 offset:12288
    ds_read_b64_tr_b16 a[182:183], v39 offset:13312
    ds_read_b64_tr_b16 a[184:185], v38 offset:14336
    ds_read_b64_tr_b16 a[186:187], v38 offset:15360
    ds_read_b64_tr_b16 a[188:189], v39 offset:14336
    ds_read_b64_tr_b16 a[190:191], v39 offset:15360
    ds_read_b64_tr_b16 a[192:193], v42 offset:0
    ds_read_b64_tr_b16 a[194:195], v42 offset:1024
    ds_read_b64_tr_b16 a[196:197], v43 offset:0
    ds_read_b64_tr_b16 a[198:199], v43 offset:1024
    ds_read_b64_tr_b16 a[200:201], v42 offset:2048
    ds_read_b64_tr_b16 a[202:203], v42 offset:3072
    ds_read_b64_tr_b16 a[204:205], v43 offset:2048
    ds_read_b64_tr_b16 a[206:207], v43 offset:3072
    s_waitcnt lgkmcnt(0)
    s_xor_b32 s57, s90, 1
    s_lshl_b32 s59, s48, 3
    s_lshl_b32 s58, s49, 1
    s_add_u32 s58, s58, s90
    s_mul_i32 s58, s58, 32
    s_add_u32 s58, s58, s59
    s_lshl_b32 s58, s58, 10
    s_add_u32 s80, s58, 5242880
    s_lshl_b32 s59, s48, 3
    s_lshl_b32 s58, s49, 1
    s_add_u32 s58, s58, s57
    s_mul_i32 s58, s58, 32
    s_add_u32 s58, s58, s59
    s_lshl_b32 s58, s58, 10
    s_add_u32 s81, s58, 5242880
    s_lshl_b32 s59, s48, 1
    s_lshl_b32 s58, s49, 1
    s_add_u32 s58, s58, s90
    s_mul_i32 s58, s58, 112
    s_add_u32 s58, s58, s59
    s_lshl_b32 s58, s58, 10
    s_add_u32 s82, s58, 16777216
    s_lshl_b32 s59, s48, 1
    s_lshl_b32 s58, s49, 1
    s_add_u32 s58, s58, s57
    s_mul_i32 s58, s58, 112
    s_add_u32 s58, s58, s59
    s_lshl_b32 s58, s58, 10
    s_add_u32 s83, s58, 16777216
    s_lshl_b32 s58, s48, 13
    s_add_u32 s70, s58, 7864320
    s_mov_b32 s93, 0x40000
    s_mov_b32 s58, 24576
    v_lshlrev_b32 v55, 2, v1
    v_cmp_gt_u32 vcc, 32, v1
    s_nop 1
    s_and_saveexec_b64 s[62:63], vcc
    buffer_load_dword v63, v55, s[40:43], s58 offen sc1
    s_waitcnt vmcnt(0)
Lfc35:
    v_cmp_ne_u32 vcc, s53, v63
    s_nop 4
    s_cbranch_vccz Lfco36
    s_sub_u32 s93, s93, 1
    s_cmp_eq_u32 s93, 0
    s_cbranch_scc1 Lfco36
    buffer_load_dword v63, v55, s[40:43], s58 offen sc1
    s_waitcnt vmcnt(0)
    s_branch Lfc35
Lfco36:
    s_mov_b64 exec, s[62:63]
    s_add_u32 s64, s80, 0
    buffer_load_dwordx4 a[32:35], v4, s[40:43], s64 offen sc1
    s_add_u32 s64, s81, 0
    buffer_load_dwordx4 a[36:39], v4, s[40:43], s64 offen sc1
    s_add_u32 s64, s80, 1024
    buffer_load_dwordx4 a[40:43], v4, s[40:43], s64 offen sc1
    s_add_u32 s64, s81, 1024
    buffer_load_dwordx4 a[44:47], v4, s[40:43], s64 offen sc1
    s_add_u32 s64, s80, 2048
    buffer_load_dwordx4 a[48:51], v4, s[40:43], s64 offen sc1
    s_add_u32 s64, s81, 2048
    buffer_load_dwordx4 a[52:55], v4, s[40:43], s64 offen sc1
    s_add_u32 s64, s80, 3072
    buffer_load_dwordx4 a[56:59], v4, s[40:43], s64 offen sc1
    s_add_u32 s64, s81, 3072
    buffer_load_dwordx4 a[60:63], v4, s[40:43], s64 offen sc1
    s_waitcnt vmcnt(0)
LJ23:
    s_waitcnt lgkmcnt(0)
    s_or_b32 s58, s2, s48
    s_cmp_lg_u32 s58, 0
    s_cbranch_scc1 Lep37
    s_mov_b32 s58, 0
    v_mov_b32 v54, s53
    v_mov_b32 v55, 0
    v_cmp_eq_u32 vcc, 0, v1
    s_nop 1
    s_and_saveexec_b64 s[62:63], vcc
    buffer_store_dword v54, v55, s[40:43], s58 offen sc1
    s_mov_b64 exec, s[62:63]
Lep37:
    s_add_u32 s64, s70, 0
    buffer_load_dwordx4 a[0:3], v4, s[40:43], s64 offen offset:0 sc1
    buffer_load_dwordx4 a[4:7], v4, s[40:43], s64 offen offset:1024 sc1
    buffer_load_dwordx4 a[8:11], v4, s[40:43], s64 offen offset:2048 sc1
    buffer_load_dwordx4 a[12:15], v4, s[40:43], s64 offen offset:3072 sc1
    s_add_u32 s64, s80, 4096
    buffer_load_dwordx4 a[64:67], v4, s[40:43], s64 offen sc1
    s_add_u32 s64, s81, 4096
    buffer_load_dwordx4 a[68:71], v4, s[40:43], s64 offen sc1
    v_lshlrev_b32 v54, 2, v2
    v_add_u32 v54, 152576, v54
    s_lshl_b32 s58, s90, 7
    v_add_u32 v55, s58, v54
    s_xor_b32 s58, s58, 128
    v_add_u32 v56, s58, v54
    ds_read_b32 v208, v55
    ds_read_b32 v210, v56
    s_waitcnt lgkmcnt(0)
    v_sub_f32 v212, 1.0, v208
    v_sub_f32 v214, 1.0, v210
    ds_read_b64_tr_b16 v[192:193], v40 offset:0
    ds_read_b64_tr_b16 v[194:195], v40 offset:1024
    ds_read_b64_tr_b16 v[196:197], v41 offset:0
    ds_read_b64_tr_b16 v[198:199], v41 offset:1024
    s_waitcnt vmcnt(5)
    v_mfma_f32_32x32x16_bf16 v[64:79], a[0:3], a[32:35], 0
    v_mfma_f32_32x32x16_bf16 v[80:95], a[0:3], a[36:39], 0
    s_waitcnt vmcnt(4)
    v_mfma_f32_32x32x16_bf16 v[96:111], a[4:7], a[40:43], 0
    v_mfma_f32_32x32x16_bf16 v[112:127], a[4:7], a[44:47], 0
    s_nop 7
    v_add_f32 v56, 0x358637bd, v72
    v_rcp_f32 v56, v56
    v_add_f32 v58, 0x358637bd, v88
    v_rcp_f32 v58, v58
    v_mul_f32 v56, v56, v208
    v_mul_f32 v58, v58, v210
    v_mul_f32 v64, v64, v56
    v_mul_f32 v65, v65, v56
    v_mul_f32 v66, v66, v56
    v_mul_f32 v67, v67, v56
    v_mul_f32 v68, v68, v56
    v_mul_f32 v69, v69, v56
    v_mul_f32 v70, v70, v56
    v_mul_f32 v71, v71, v56
    v_cvt_pk_bf16_f32 v46, v64, v65
    v_cvt_pk_bf16_f32 v47, v66, v67
    v_cvt_pk_bf16_f32 v48, v68, v69
    v_cvt_pk_bf16_f32 v49, v70, v71
    v_mul_f32 v80, v80, v58
    v_mul_f32 v81, v81, v58
    v_mul_f32 v82, v82, v58
    v_mul_f32 v83, v83, v58
    v_mul_f32 v84, v84, v58
    v_mul_f32 v85, v85, v58
    v_mul_f32 v86, v86, v58
    v_mul_f32 v87, v87, v58
    v_cvt_pk_bf16_f32 v50, v80, v81
    v_cvt_pk_bf16_f32 v51, v82, v83
    v_cvt_pk_bf16_f32 v52, v84, v85
    v_cvt_pk_bf16_f32 v53, v86, v87
    s_waitcnt lgkmcnt(0)
    s_waitcnt vmcnt(3)
    v_mfma_f32_32x32x16_bf16 v[128:143], v[192:195], v[46:49], 0
    ds_read_b64_tr_b16 v[200:201], v40 offset:2048
    ds_read_b64_tr_b16 v[202:203], v40 offset:3072
    ds_read_b64_tr_b16 v[204:205], v41 offset:2048
    ds_read_b64_tr_b16 v[206:207], v41 offset:3072
    v_add_f32 v56, 0x358637bd, v96
    v_rcp_f32 v56, v56
    s_add_u32 s64, s70, 4096
    buffer_load_dwordx4 a[16:19], v4, s[40:43], s64 offen offset:0 sc1
    v_mfma_f32_32x32x16_bf16 v[144:159], v[196:199], v[46:49], 0
    v_add_f32 v58, 0x358637bd, v112
    v_rcp_f32 v58, v58
    v_mul_f32 v56, v56, v208
    v_mul_f32 v58, v58, v210
    v_mul_f32 v104, v104, v56
    v_mul_f32 v105, v105, v56
    v_mfma_f32_32x32x16_bf16 v[160:175], v[192:195], v[50:53], 0
    v_mul_f32 v106, v106, v56
    v_mul_f32 v107, v107, v56
    buffer_load_dwordx4 a[20:23], v4, s[40:43], s64 offen offset:1024 sc1
    v_mul_f32 v108, v108, v56
    v_mul_f32 v109, v109, v56
    v_mul_f32 v110, v110, v56
    v_mfma_f32_32x32x16_bf16 v[176:191], v[196:199], v[50:53], 0
    v_mul_f32 v111, v111, v56
    v_cvt_pk_bf16_f32 v248, v104, v105
    v_cvt_pk_bf16_f32 v249, v106, v107
    v_cvt_pk_bf16_f32 v250, v108, v109
    v_cvt_pk_bf16_f32 v251, v110, v111
    buffer_load_dwordx4 a[24:27], v4, s[40:43], s64 offen offset:2048 sc1
    v_mfma_f32_32x32x16_bf16 v[64:79], a[8:11], a[48:51], 0
    v_mul_f32 v120, v120, v58
    v_mul_f32 v121, v121, v58
    v_mul_f32 v122, v122, v58
    v_mul_f32 v123, v123, v58
    v_mul_f32 v124, v124, v58
    v_mul_f32 v125, v125, v58
    v_mfma_f32_32x32x16_bf16 v[80:95], a[8:11], a[52:55], 0
    v_mul_f32 v126, v126, v58
    v_mul_f32 v127, v127, v58
    v_cvt_pk_bf16_f32 v252, v120, v121
    v_cvt_pk_bf16_f32 v253, v122, v123
    v_cvt_pk_bf16_f32 v254, v124, v125
    v_cvt_pk_bf16_f32 v255, v126, v127
    s_waitcnt lgkmcnt(0)
    s_waitcnt vmcnt(5)
    v_mfma_f32_32x32x16_bf16 v[128:143], v[200:203], v[248:251], v[128:143]
    ds_read_b64_tr_b16 v[192:193], v40 offset:4096
    ds_read_b64_tr_b16 v[194:195], v40 offset:5120
    ds_read_b64_tr_b16 v[196:197], v41 offset:4096
    ds_read_b64_tr_b16 v[198:199], v41 offset:5120
    v_add_f32 v56, 0x358637bd, v72
    v_rcp_f32 v56, v56
    buffer_load_dwordx4 a[28:31], v4, s[40:43], s64 offen offset:3072 sc1
    v_mfma_f32_32x32x16_bf16 v[144:159], v[204:207], v[248:251], v[144:159]
    v_add_f32 v58, 0x358637bd, v88
    v_rcp_f32 v58, v58
    v_mul_f32 v56, v56, v208
    v_mul_f32 v58, v58, v210
    v_mul_f32 v64, v64, v56
    v_mul_f32 v65, v65, v56
    v_mfma_f32_32x32x16_bf16 v[160:175], v[200:203], v[252:255], v[160:175]
    v_mul_f32 v66, v66, v56
    v_mul_f32 v67, v67, v56
    s_add_u32 s64, s80, 5120
    buffer_load_dwordx4 a[72:75], v4, s[40:43], s64 offen sc1
    v_mul_f32 v68, v68, v56
    v_mul_f32 v69, v69, v56
    v_mul_f32 v70, v70, v56
    v_mfma_f32_32x32x16_bf16 v[176:191], v[204:207], v[252:255], v[176:191]
    v_mul_f32 v71, v71, v56
    v_cvt_pk_bf16_f32 v46, v64, v65
    v_cvt_pk_bf16_f32 v47, v66, v67
    v_cvt_pk_bf16_f32 v48, v68, v69
    v_cvt_pk_bf16_f32 v49, v70, v71
    s_add_u32 s64, s81, 5120
    buffer_load_dwordx4 a[76:79], v4, s[40:43], s64 offen sc1
    v_mfma_f32_32x32x16_bf16 v[96:111], a[12:15], a[56:59], 0
    v_mul_f32 v80, v80, v58
    v_mul_f32 v81, v81, v58
    v_mul_f32 v82, v82, v58
    v_mul_f32 v83, v83, v58
    v_mul_f32 v84, v84, v58
    v_mul_f32 v85, v85, v58
    v_mfma_f32_32x32x16_bf16 v[112:127], a[12:15], a[60:63], 0
    v_mul_f32 v86, v86, v58
    v_mul_f32 v87, v87, v58
    v_cvt_pk_bf16_f32 v50, v80, v81
    v_cvt_pk_bf16_f32 v51, v82, v83
    v_cvt_pk_bf16_f32 v52, v84, v85
    v_cvt_pk_bf16_f32 v53, v86, v87
    s_waitcnt lgkmcnt(0)
    s_waitcnt vmcnt(6)
    s_waitcnt vmcnt(5)
    v_mfma_f32_32x32x16_bf16 v[128:143], v[192:195], v[46:49], v[128:143]
    ds_read_b64_tr_b16 v[200:201], v40 offset:6144
    ds_read_b64_tr_b16 v[202:203], v40 offset:7168
    ds_read_b64_tr_b16 v[204:205], v41 offset:6144
    ds_read_b64_tr_b16 v[206:207], v41 offset:7168
    v_add_f32 v56, 0x358637bd, v96
    v_rcp_f32 v56, v56
    s_add_u32 s64, s80, 6144
    buffer_load_dwordx4 a[80:83], v4, s[40:43], s64 offen sc1
    v_mfma_f32_32x32x16_bf16 v[144:159], v[196:199], v[46:49], v[144:159]
    v_add_f32 v58, 0x358637bd, v112
    v_rcp_f32 v58, v58
    v_mul_f32 v56, v56, v208
    v_mul_f32 v58, v58, v210
    v_mul_f32 v104, v104, v56
    v_mul_f32 v105, v105, v56
    v_mfma_f32_32x32x16_bf16 v[160:175], v[192:195], v[50:53], v[160:175]
    v_mul_f32 v106, v106, v56
    v_mul_f32 v107, v107, v56
    s_add_u32 s64, s81, 6144
    buffer_load_dwordx4 a[84:87], v4, s[40:43], s64 offen sc1
    v_mul_f32 v108, v108, v56
    v_mul_f32 v109, v109, v56
    v_mul_f32 v110, v110, v56
    v_mfma_f32_32x32x16_bf16 v[176:191], v[196:199], v[50:53], v[176:191]
    v_mul_f32 v111, v111, v56
    v_cvt_pk_bf16_f32 v248, v104, v105
    v_cvt_pk_bf16_f32 v249, v106, v107
    v_cvt_pk_bf16_f32 v250, v108, v109
    v_cvt_pk_bf16_f32 v251, v110, v111
    s_add_u32 s64, s80, 7168
    buffer_load_dwordx4 a[88:91], v4, s[40:43], s64 offen sc1
    v_mfma_f32_32x32x16_bf16 v[64:79], a[16:19], a[64:67], 0
    v_mul_f32 v120, v120, v58
    v_mul_f32 v121, v121, v58
    v_mul_f32 v122, v122, v58
    v_mul_f32 v123, v123, v58
    v_mul_f32 v124, v124, v58
    v_mul_f32 v125, v125, v58
    v_mfma_f32_32x32x16_bf16 v[80:95], a[16:19], a[68:71], 0
    v_mul_f32 v126, v126, v58
    v_mul_f32 v127, v127, v58
    v_cvt_pk_bf16_f32 v252, v120, v121
    v_cvt_pk_bf16_f32 v253, v122, v123
    v_cvt_pk_bf16_f32 v254, v124, v125
    v_cvt_pk_bf16_f32 v255, v126, v127
    s_waitcnt lgkmcnt(0)
    s_waitcnt vmcnt(3)
    v_mfma_f32_32x32x16_bf16 v[128:143], v[200:203], v[248:251], v[128:143]
    ds_read_b64_tr_b16 v[192:193], v40 offset:8192
    ds_read_b64_tr_b16 v[194:195], v40 offset:9216
    ds_read_b64_tr_b16 v[196:197], v41 offset:8192
    ds_read_b64_tr_b16 v[198:199], v41 offset:9216
    v_add_f32 v56, 0x358637bd, v72
    v_rcp_f32 v56, v56
    s_add_u32 s64, s81, 7168
    buffer_load_dwordx4 a[92:95], v4, s[40:43], s64 offen sc1
    v_mfma_f32_32x32x16_bf16 v[144:159], v[204:207], v[248:251], v[144:159]
    v_add_f32 v58, 0x358637bd, v88
    v_rcp_f32 v58, v58
    v_mul_f32 v56, v56, v208
    v_mul_f32 v58, v58, v210
    v_mul_f32 v64, v64, v56
    v_mul_f32 v65, v65, v56
    v_mfma_f32_32x32x16_bf16 v[160:175], v[200:203], v[252:255], v[160:175]
    v_mul_f32 v66, v66, v56
    v_mul_f32 v67, v67, v56
    s_lshl_b32 s64, s48, 14
    s_add_u32 m0, s64, 0
    s_lshl_b32 s64, s48, 15
    s_lshl_b32 s61, s50, 7
    s_add_u32 s64, s64, s61
    s_add_u32 s64, s64, 655360
    buffer_load_dwordx4 v10, s[32:35], s64 offen lds
    v_mul_f32 v68, v68, v56
    v_mul_f32 v69, v69, v56
    v_mul_f32 v70, v70, v56
    v_mfma_f32_32x32x16_bf16 v[176:191], v[204:207], v[252:255], v[176:191]
    v_mul_f32 v71, v71, v56
    v_cvt_pk_bf16_f32 v46, v64, v65
    v_cvt_pk_bf16_f32 v47, v66, v67
    v_cvt_pk_bf16_f32 v48, v68, v69
    v_cvt_pk_bf16_f32 v49, v70, v71
    buffer_load_dwordx4 v11, s[32:35], s64 offen offset:1024 lds
    v_mfma_f32_32x32x16_bf16 v[96:111], a[20:23], a[72:75], 0
    v_mul_f32 v80, v80, v58
    v_mul_f32 v81, v81, v58
    v_mul_f32 v82, v82, v58
    v_mul_f32 v83, v83, v58
    v_mul_f32 v84, v84, v58
    v_mul_f32 v85, v85, v58
    v_mfma_f32_32x32x16_bf16 v[112:127], a[20:23], a[76:79], 0
    v_mul_f32 v86, v86, v58
    v_mul_f32 v87, v87, v58
    v_cvt_pk_bf16_f32 v50, v80, v81
    v_cvt_pk_bf16_f32 v51, v82, v83
    v_cvt_pk_bf16_f32 v52, v84, v85
    v_cvt_pk_bf16_f32 v53, v86, v87
    s_waitcnt lgkmcnt(0)
    s_waitcnt vmcnt(4)
    v_mfma_f32_32x32x16_bf16 v[128:143], v[192:195], v[46:49], v[128:143]
    ds_read_b64_tr_b16 v[200:201], v40 offset:10240
    ds_read_b64_tr_b16 v[202:203], v40 offset:11264
    ds_read_b64_tr_b16 v[204:205], v41 offset:10240
    ds_read_b64_tr_b16 v[206:207], v41 offset:11264
    v_add_f32 v56, 0x358637bd, v96
    v_rcp_f32 v56, v56
    buffer_load_dwordx4 v12, s[32:35], s64 offen offset:2048 lds
    v_mfma_f32_32x32x16_bf16 v[144:159], v[196:199], v[46:49], v[144:159]
    v_add_f32 v58, 0x358637bd, v112
    v_rcp_f32 v58, v58
    v_mul_f32 v56, v56, v208
    v_mul_f32 v58, v58, v210
    v_mul_f32 v104, v104, v56
    v_mul_f32 v105, v105, v56
    v_mfma_f32_32x32x16_bf16 v[160:175], v[192:195], v[50:53], v[160:175]
    v_mul_f32 v106, v106, v56
    v_mul_f32 v107, v107, v56
    buffer_load_dwordx4 v13, s[32:35], s64 offen offset:3072 lds
    v_mul_f32 v108, v108, v56
    v_mul_f32 v109, v109, v56
    v_mul_f32 v110, v110, v56
    v_mfma_f32_32x32x16_bf16 v[176:191], v[196:199], v[50:53], v[176:191]
    v_mul_f32 v111, v111, v56
    v_cvt_pk_bf16_f32 v248, v104, v105
    v_cvt_pk_bf16_f32 v249, v106, v107
    v_cvt_pk_bf16_f32 v250, v108, v109
    v_cvt_pk_bf16_f32 v251, v110, v111
    s_lshl_b32 s64, s48, 14
    s_add_u32 m0, s64, 4096
    s_lshl_b32 s64, s48, 15
    s_lshl_b32 s61, s50, 7
    s_add_u32 s64, s64, s61
    s_add_u32 s64, s64, 786432
    buffer_load_dwordx4 v10, s[32:35], s64 offen lds
    v_mfma_f32_32x32x16_bf16 v[64:79], a[24:27], a[80:83], 0
    v_mul_f32 v120, v120, v58
    v_mul_f32 v121, v121, v58
    v_mul_f32 v122, v122, v58
    v_mul_f32 v123, v123, v58
    v_mul_f32 v124, v124, v58
    v_mul_f32 v125, v125, v58
    v_mfma_f32_32x32x16_bf16 v[80:95], a[24:27], a[84:87], 0
    v_mul_f32 v126, v126, v58
    v_mul_f32 v127, v127, v58
    v_cvt_pk_bf16_f32 v252, v120, v121
    v_cvt_pk_bf16_f32 v253, v122, v123
    v_cvt_pk_bf16_f32 v254, v124, v125
    v_cvt_pk_bf16_f32 v255, v126, v127
    s_waitcnt lgkmcnt(0)
    s_waitcnt vmcnt(5)
    v_mfma_f32_32x32x16_bf16 v[128:143], v[200:203], v[248:251], v[128:143]
    ds_read_b64_tr_b16 v[192:193], v40 offset:12288
    ds_read_b64_tr_b16 v[194:195], v40 offset:13312
    ds_read_b64_tr_b16 v[196:197], v41 offset:12288
    ds_read_b64_tr_b16 v[198:199], v41 offset:13312
    v_add_f32 v56, 0x358637bd, v72
    v_rcp_f32 v56, v56
    buffer_load_dwordx4 v11, s[32:35], s64 offen offset:1024 lds
    v_mfma_f32_32x32x16_bf16 v[144:159], v[204:207], v[248:251], v[144:159]
    v_add_f32 v58, 0x358637bd, v88
    v_rcp_f32 v58, v58
    v_mul_f32 v56, v56, v208
    v_mul_f32 v58, v58, v210
    v_mul_f32 v64, v64, v56
    v_mul_f32 v65, v65, v56
    v_mfma_f32_32x32x16_bf16 v[160:175], v[200:203], v[252:255], v[160:175]
    v_mul_f32 v66, v66, v56
    v_mul_f32 v67, v67, v56
    buffer_load_dwordx4 v12, s[32:35], s64 offen offset:2048 lds
    v_mul_f32 v68, v68, v56
    v_mul_f32 v69, v69, v56
    v_mul_f32 v70, v70, v56
    v_mfma_f32_32x32x16_bf16 v[176:191], v[204:207], v[252:255], v[176:191]
    v_mul_f32 v71, v71, v56
    v_cvt_pk_bf16_f32 v46, v64, v65
    v_cvt_pk_bf16_f32 v47, v66, v67
    v_cvt_pk_bf16_f32 v48, v68, v69
    v_cvt_pk_bf16_f32 v49, v70, v71
    buffer_load_dwordx4 v13, s[32:35], s64 offen offset:3072 lds
    v_mfma_f32_32x32x16_bf16 v[96:111], a[28:31], a[88:91], 0
    v_mul_f32 v80, v80, v58
    v_mul_f32 v81, v81, v58
    v_mul_f32 v82, v82, v58
    v_mul_f32 v83, v83, v58
    v_mul_f32 v84, v84, v58
    v_mul_f32 v85, v85, v58
    v_mfma_f32_32x32x16_bf16 v[112:127], a[28:31], a[92:95], 0
    v_mul_f32 v86, v86, v58
    v_mul_f32 v87, v87, v58
    v_cvt_pk_bf16_f32 v50, v80, v81
    v_cvt_pk_bf16_f32 v51, v82, v83
    v_cvt_pk_bf16_f32 v52, v84, v85
    v_cvt_pk_bf16_f32 v53, v86, v87
    s_waitcnt lgkmcnt(0)
    s_lshl_b32 s58, s51, 7
    s_add_u32 s58, s58, 16384
    s_mov_b32 s79, s58
    v_min_u32 v63, 13, v1
    v_lshlrev_b32 v63, 2, v63
    buffer_load_dword v63, v63, s[40:43], s79 offen sc1
    v_mfma_f32_32x32x16_bf16 v[128:143], v[192:195], v[46:49], v[128:143]
    ds_read_b64_tr_b16 v[200:201], v40 offset:14336
    ds_read_b64_tr_b16 v[202:203], v40 offset:15360
    ds_read_b64_tr_b16 v[204:205], v41 offset:14336
    ds_read_b64_tr_b16 v[206:207], v41 offset:15360
    v_add_f32 v56, 0x358637bd, v96
    v_rcp_f32 v56, v56
    v_add_f32 v58, 0x358637bd, v112
    v_rcp_f32 v58, v58
    v_mul_f32 v56, v56, v208
    v_mfma_f32_32x32x16_bf16 v[144:159], v[196:199], v[46:49], v[144:159]
    v_mul_f32 v58, v58, v210
    v_mul_f32 v104, v104, v56
    v_mul_f32 v105, v105, v56
    v_mul_f32 v106, v106, v56
    v_mul_f32 v107, v107, v56
    v_mul_f32 v108, v108, v56
    v_mul_f32 v109, v109, v56
    v_mul_f32 v110, v110, v56
    v_mfma_f32_32x32x16_bf16 v[160:175], v[192:195], v[50:53], v[160:175]
    v_mul_f32 v111, v111, v56
    v_cvt_pk_bf16_f32 v248, v104, v105
    v_cvt_pk_bf16_f32 v249, v106, v107
    v_cvt_pk_bf16_f32 v250, v108, v109
    v_cvt_pk_bf16_f32 v251, v110, v111
    v_mul_f32 v120, v120, v58
    v_mul_f32 v121, v121, v58
    v_mul_f32 v122, v122, v58
    v_mul_f32 v123, v123, v58
    v_mfma_f32_32x32x16_bf16 v[176:191], v[196:199], v[50:53], v[176:191]
    v_mul_f32 v124, v124, v58
    v_mul_f32 v125, v125, v58
    v_mul_f32 v126, v126, v58
    v_mul_f32 v127, v127, v58
    v_cvt_pk_bf16_f32 v252, v120, v121
    v_cvt_pk_bf16_f32 v253, v122, v123
    v_cvt_pk_bf16_f32 v254, v124, v125
    v_cvt_pk_bf16_f32 v255, v126, v127
    s_waitcnt lgkmcnt(0)
    v_mfma_f32_32x32x16_bf16 v[128:143], v[200:203], v[248:251], v[128:143]
    v_mfma_f32_32x32x16_bf16 v[144:159], v[204:207], v[248:251], v[144:159]
    v_mfma_f32_32x32x16_bf16 v[160:175], v[200:203], v[252:255], v[160:175]
    v_mfma_f32_32x32x16_bf16 v[176:191], v[204:207], v[252:255], v[176:191]
    s_lshl_b32 s64, s48, 14
    s_add_u32 m0, s64, 8192
    s_lshl_b32 s64, s48, 15
    s_lshl_b32 s61, s50, 7
    s_add_u32 s64, s64, s61
    s_add_u32 s64, s64, 917504
    buffer_load_dwordx4 v10, s[32:35], s64 offen lds
    buffer_load_dwordx4 v11, s[32:35], s64 offen offset:1024 lds
    buffer_load_dwordx4 v12, s[32:35], s64 offen offset:2048 lds
    buffer_load_dwordx4 v13, s[32:35], s64 offen offset:3072 lds
    s_lshl_b32 s64, s48, 14
    s_add_u32 m0, s64, 12288
    s_lshl_b32 s64, s48, 15
    s_lshl_b32 s61, s50, 7
    s_add_u32 s64, s64, s61
    s_add_u32 s64, s64, 1048576
    buffer_load_dwordx4 v10, s[32:35], s64 offen lds
    buffer_load_dwordx4 v11, s[32:35], s64 offen offset:1024 lds
    buffer_load_dwordx4 v12, s[32:35], s64 offen offset:2048 lds
    buffer_load_dwordx4 v13, s[32:35], s64 offen offset:3072 lds
    s_lshl_b32 s64, s48, 12
    s_add_u32 m0, s64, 135168
    s_lshl_b32 s64, s48, 15
    s_lshl_b32 s61, s50, 7
    s_add_u32 s64, s64, s61
    s_add_u32 s64, s64, 1179648
    buffer_load_dwordx4 v10, s[32:35], s64 offen lds
    buffer_load_dwordx4 v11, s[32:35], s64 offen offset:1024 lds
    buffer_load_dwordx4 v12, s[32:35], s64 offen offset:2048 lds
    buffer_load_dwordx4 v13, s[32:35], s64 offen offset:3072 lds
    s_lshl_b32 s64, s48, 14
    s_add_u32 m0, s64, 69632
    s_lshl_b32 s64, s48, 15
    s_lshl_b32 s61, s50, 7
    s_add_u32 s64, s64, s61
    s_add_u32 s64, s64, 1310720
    buffer_load_dwordx4 v10, s[32:35], s64 offen lds
    buffer_load_dwordx4 v11, s[32:35], s64 offen offset:1024 lds
    buffer_load_dwordx4 v12, s[32:35], s64 offen offset:2048 lds
    buffer_load_dwordx4 v13, s[32:35], s64 offen offset:3072 lds
    s_lshl_b32 s64, s48, 14
    s_add_u32 m0, s64, 73728
    s_lshl_b32 s64, s48, 15
    s_lshl_b32 s61, s50, 7
    s_add_u32 s64, s64, s61
    s_add_u32 s64, s64, 1441792
    buffer_load_dwordx4 v10, s[32:35], s64 offen lds
    buffer_load_dwordx4 v11, s[32:35], s64 offen offset:1024 lds
    buffer_load_dwordx4 v12, s[32:35], s64 offen offset:2048 lds
    buffer_load_dwordx4 v13, s[32:35], s64 offen offset:3072 lds
    s_lshl_b32 s64, s48, 14
    s_add_u32 m0, s64, 77824
    s_lshl_b32 s64, s48, 15
    s_lshl_b32 s61, s50, 7
    s_add_u32 s64, s64, s61
    s_add_u32 s64, s64, 1572864
    buffer_load_dwordx4 v10, s[32:35], s64 offen lds
    buffer_load_dwordx4 v11, s[32:35], s64 offen offset:1024 lds
    buffer_load_dwordx4 v12, s[32:35], s64 offen offset:2048 lds
    buffer_load_dwordx4 v13, s[32:35], s64 offen offset:3072 lds
    s_lshl_b32 s64, s48, 14
    s_add_u32 m0, s64, 81920
    s_lshl_b32 s64, s48, 15
    s_lshl_b32 s61, s50, 7
    s_add_u32 s64, s64, s61
    s_add_u32 s64, s64, 1703936
    buffer_load_dwordx4 v10, s[32:35], s64 offen lds
    buffer_load_dwordx4 v11, s[32:35], s64 offen offset:1024 lds
    buffer_load_dwordx4 v12, s[32:35], s64 offen offset:2048 lds
    buffer_load_dwordx4 v13, s[32:35], s64 offen offset:3072 lds
    s_waitcnt vmcnt(28)
    s_mov_b32 s93, 0x40000
Lfw38:
    v_cmp_ne_u32 vcc, s53, v63
    s_nop 4
    s_cbranch_vccz Lfwo39
    s_sub_u32 s93, s93, 1
    s_cmp_eq_u32 s93, 0
    s_cbranch_scc1 Lfwo39
    v_min_u32 v55, 13, v1
    v_lshlrev_b32 v55, 2, v55
    buffer_load_dword v63, v55, s[40:43], s79 offen sc1
    s_waitcnt vmcnt(0)
    s_branch Lfw38
Lfwo39:
    s_add_u32 s64, s82, 0
    buffer_load_dwordx4 a[0:3], v4, s[40:43], s64 offen sc1
    s_add_u32 s64, s83, 0
    buffer_load_dwordx4 a[4:7], v4, s[40:43], s64 offen sc1
    s_add_u32 s64, s82, 1024
    buffer_load_dwordx4 a[8:11], v4, s[40:43], s64 offen sc1
    s_add_u32 s64, s83, 1024
    buffer_load_dwordx4 a[12:15], v4, s[40:43], s64 offen sc1
    s_add_u32 s64, s82, 8192
    buffer_load_dwordx4 a[16:19], v4, s[40:43], s64 offen sc1
    s_add_u32 s64, s83, 8192
    buffer_load_dwordx4 a[20:23], v4, s[40:43], s64 offen sc1
    s_add_u32 s64, s82, 9216
    buffer_load_dwordx4 a[24:27], v4, s[40:43], s64 offen sc1
    s_add_u32 s64, s83, 9216
    buffer_load_dwordx4 a[28:31], v4, s[40:43], s64 offen sc1
    s_add_u32 s64, s82, 16384
    buffer_load_dwordx4 a[32:35], v4, s[40:43], s64 offen sc1
    s_add_u32 s64, s83, 16384
    buffer_load_dwordx4 a[36:39], v4, s[40:43], s64 offen sc1
    s_waitcnt vmcnt(8)
    v_mfma_f32_32x32x16_bf16 v[64:79], a[128:131], a[0:3], 0
    s_add_u32 s64, s82, 17408
    buffer_load_dwordx4 a[40:43], v4, s[40:43], s64 offen sc1
    v_mfma_f32_32x32x16_bf16 v[80:95], a[132:135], a[0:3], 0
    v_mfma_f32_32x32x16_bf16 v[96:111], a[128:131], a[4:7], 0
    s_add_u32 s64, s83, 17408
    buffer_load_dwordx4 a[44:47], v4, s[40:43], s64 offen sc1
    v_mfma_f32_32x32x16_bf16 v[112:127], a[132:135], a[4:7], 0
    s_waitcnt vmcnt(8)
    v_mfma_f32_32x32x16_bf16 v[64:79], a[136:139], a[8:11], v[64:79]
    s_add_u32 s64, s82, 24576
    buffer_load_dwordx4 a[48:51], v4, s[40:43], s64 offen sc1
    v_mfma_f32_32x32x16_bf16 v[80:95], a[140:143], a[8:11], v[80:95]
    v_mfma_f32_32x32x16_bf16 v[96:111], a[136:139], a[12:15], v[96:111]
    s_add_u32 s64, s83, 24576
    buffer_load_dwordx4 a[52:55], v4, s[40:43], s64 offen sc1
    v_mfma_f32_32x32x16_bf16 v[112:127], a[140:143], a[12:15], v[112:127]
    s_waitcnt vmcnt(8)
    v_mfma_f32_32x32x16_bf16 v[64:79], a[144:147], a[16:19], v[64:79]
    s_add_u32 s64, s82, 25600
    buffer_load_dwordx4 a[56:59], v4, s[40:43], s64 offen sc1
    v_mfma_f32_32x32x16_bf16 v[80:95], a[148:151], a[16:19], v[80:95]
    v_mfma_f32_32x32x16_bf16 v[96:111], a[144:147], a[20:23], v[96:111]
    s_add_u32 s64, s83, 25600
    buffer_load_dwordx4 a[60:63], v4, s[40:43], s64 offen sc1
    v_mfma_f32_32x32x16_bf16 v[112:127], a[148:151], a[20:23], v[112:127]
    s_waitcnt vmcnt(8)
    v_mfma_f32_32x32x16_bf16 v[64:79], a[152:155], a[24:27], v[64:79]
    s_add_u32 s64, s82, 32768
    buffer_load_dwordx4 a[64:67], v4, s[40:43], s64 offen sc1
    v_mfma_f32_32x32x16_bf16 v[80:95], a[156:159], a[24:27], v[80:95]
    v_mfma_f32_32x32x16_bf16 v[96:111], a[152:155], a[28:31], v[96:111]
    s_add_u32 s64, s83, 32768
    buffer_load_dwordx4 a[68:71], v4, s[40:43], s64 offen sc1
    v_mfma_f32_32x32x16_bf16 v[112:127], a[156:159], a[28:31], v[112:127]
    s_waitcnt vmcnt(8)
    v_mfma_f32_32x32x16_bf16 v[64:79], a[160:163], a[32:35], v[64:79]
    s_add_u32 s64, s82, 33792
    buffer_load_dwordx4 a[72:75], v4, s[40:43], s64 offen sc1
    v_mfma_f32_32x32x16_bf16 v[80:95], a[164:167], a[32:35], v[80:95]
    v_mfma_f32_32x32x16_bf16 v[96:111], a[160:163], a[36:39], v[96:111]
    s_add_u32 s64, s83, 33792
    buffer_load_dwordx4 a[76:79], v4, s[40:43], s64 offen sc1
    v_mfma_f32_32x32x16_bf16 v[112:127], a[164:167], a[36:39], v[112:127]
    s_waitcnt vmcnt(8)
    v_mfma_f32_32x32x16_bf16 v[64:79], a[168:171], a[40:43], v[64:79]
    s_add_u32 s64, s82, 40960
    buffer_load_dwordx4 a[80:83], v4, s[40:43], s64 offen sc1
    v_mfma_f32_32x32x16_bf16 v[80:95], a[172:175], a[40:43], v[80:95]
    v_mfma_f32_32x32x16_bf16 v[96:111], a[168:171], a[44:47], v[96:111]
    s_add_u32 s64, s83, 40960
    buffer_load_dwordx4 a[84:87], v4, s[40:43], s64 offen sc1
    v_mfma_f32_32x32x16_bf16 v[112:127], a[172:175], a[44:47], v[112:127]
    s_waitcnt vmcnt(8)
    v_mfma_f32_32x32x16_bf16 v[64:79], a[176:179], a[48:51], v[64:79]
    s_add_u32 s64, s82, 41984
    buffer_load_dwordx4 a[88:91], v4, s[40:43], s64 offen sc1
    v_mfma_f32_32x32x16_bf16 v[80:95], a[180:183], a[48:51], v[80:95]
    v_mfma_f32_32x32x16_bf16 v[96:111], a[176:179], a[52:55], v[96:111]
    s_add_u32 s64, s83, 41984
    buffer_load_dwordx4 a[92:95], v4, s[40:43], s64 offen sc1
    v_mfma_f32_32x32x16_bf16 v[112:127], a[180:183], a[52:55], v[112:127]
    s_waitcnt vmcnt(8)
    v_mfma_f32_32x32x16_bf16 v[64:79], a[184:187], a[56:59], v[64:79]
    s_add_u32 s64, s82, 49152
    buffer_load_dwordx4 a[96:99], v4, s[40:43], s64 offen sc1
    v_mfma_f32_32x32x16_bf16 v[80:95], a[188:191], a[56:59], v[80:95]
    v_mfma_f32_32x32x16_bf16 v[96:111], a[184:187], a[60:63], v[96:111]
    s_add_u32 s64, s83, 49152
    buffer_load_dwordx4 a[100:103], v4, s[40:43], s64 offen sc1
    v_mfma_f32_32x32x16_bf16 v[112:127], a[188:191], a[60:63], v[112:127]
    s_waitcnt vmcnt(8)
    v_mfma_f32_32x32x16_bf16 v[64:79], a[192:195], a[64:67], v[64:79]
    s_add_u32 s64, s82, 50176
    buffer_load_dwordx4 a[104:107], v4, s[40:43], s64 offen sc1
    ds_read_b64_tr_b16 v[200:201], v38 offset:0
    v_mfma_f32_32x32x16_bf16 v[80:95], a[196:199], a[64:67], v[80:95]
    ds_read_b64_tr_b16 v[202:203], v38 offset:1024
    v_mfma_f32_32x32x16_bf16 v[96:111], a[192:195], a[68:71], v[96:111]
    s_add_u32 s64, s83, 50176
    buffer_load_dwordx4 a[108:111], v4, s[40:43], s64 offen sc1
    ds_read_b64_tr_b16 v[204:205], v39 offset:0
    v_mfma_f32_32x32x16_bf16 v[112:127], a[196:199], a[68:71], v[112:127]
    ds_read_b64_tr_b16 v[206:207], v39 offset:1024
    s_waitcnt vmcnt(8)
    v_mfma_f32_32x32x16_bf16 v[64:79], a[200:203], a[72:75], v[64:79]
    s_add_u32 s64, s82, 57344
    buffer_load_dwordx4 a[112:115], v4, s[40:43], s64 offen sc1
    ds_read_b64_tr_b16 v[216:217], v38 offset:2048
    v_mfma_f32_32x32x16_bf16 v[80:95], a[204:207], a[72:75], v[80:95]
    ds_read_b64_tr_b16 v[218:219], v38 offset:3072
    v_mfma_f32_32x32x16_bf16 v[96:111], a[200:203], a[76:79], v[96:111]
    s_add_u32 s64, s83, 57344
    buffer_load_dwordx4 a[116:119], v4, s[40:43], s64 offen sc1
    ds_read_b64_tr_b16 v[220:221], v39 offset:2048
    v_mfma_f32_32x32x16_bf16 v[112:127], a[204:207], a[76:79], v[112:127]
    ds_read_b64_tr_b16 v[222:223], v39 offset:3072
    s_waitcnt lgkmcnt(4)
    s_waitcnt vmcnt(8)
    v_mfma_f32_32x32x16_bf16 v[64:79], v[200:203], a[80:83], v[64:79]
    s_add_u32 s64, s82, 58368
    buffer_load_dwordx4 a[120:123], v4, s[40:43], s64 offen sc1
    ds_read_b64_tr_b16 v[192:193], v38 offset:4096
    v_mfma_f32_32x32x16_bf16 v[80:95], v[204:207], a[80:83], v[80:95]
    ds_read_b64_tr_b16 v[194:195], v38 offset:5120
    v_mfma_f32_32x32x16_bf16 v[96:111], v[200:203], a[84:87], v[96:111]
    s_add_u32 s64, s83, 58368
    buffer_load_dwordx4 a[124:127], v4, s[40:43], s64 offen sc1
    ds_read_b64_tr_b16 v[196:197], v39 offset:4096
    v_mfma_f32_32x32x16_bf16 v[112:127], v[204:207], a[84:87], v[112:127]
    ds_read_b64_tr_b16 v[198:199], v39 offset:5120
    s_waitcnt lgkmcnt(4)
    s_waitcnt vmcnt(8)
    v_mfma_f32_32x32x16_bf16 v[64:79], v[216:219], a[88:91], v[64:79]
    s_add_u32 s64, s82, 65536
    buffer_load_dwordx4 a[0:3], v4, s[40:43], s64 offen sc1
    ds_read_b64_tr_b16 v[200:201], v38 offset:6144
    v_mfma_f32_32x32x16_bf16 v[80:95], v[220:223], a[88:91], v[80:95]
    ds_read_b64_tr_b16 v[202:203], v38 offset:7168
    v_mfma_f32_32x32x16_bf16 v[96:111], v[216:219], a[92:95], v[96:111]
    s_add_u32 s64, s83, 65536
    buffer_load_dwordx4 a[4:7], v4, s[40:43], s64 offen sc1
    ds_read_b64_tr_b16 v[204:205], v39 offset:6144
    v_mfma_f32_32x32x16_bf16 v[112:127], v[220:223], a[92:95], v[112:127]
    ds_read_b64_tr_b16 v[206:207], v39 offset:7168
    s_waitcnt lgkmcnt(4)
    s_waitcnt vmcnt(8)
    v_mfma_f32_32x32x16_bf16 v[64:79], v[192:195], a[96:99], v[64:79]
    s_add_u32 s64, s82, 66560
    buffer_load_dwordx4 a[8:11], v4, s[40:43], s64 offen sc1
    ds_read_b64_tr_b16 v[216:217], v38 offset:8192
    v_mfma_f32_32x32x16_bf16 v[80:95], v[196:199], a[96:99], v[80:95]
    ds_read_b64_tr_b16 v[218:219], v38 offset:9216
    v_mfma_f32_32x32x16_bf16 v[96:111], v[192:195], a[100:103], v[96:111]
    s_add_u32 s64, s83, 66560
    buffer_load_dwordx4 a[12:15], v4, s[40:43], s64 offen sc1
    ds_read_b64_tr_b16 v[220:221], v39 offset:8192
    v_mfma_f32_32x32x16_bf16 v[112:127], v[196:199], a[100:103], v[112:127]
    ds_read_b64_tr_b16 v[222:223], v39 offset:9216
    s_waitcnt lgkmcnt(4)
    s_waitcnt vmcnt(8)
    v_mfma_f32_32x32x16_bf16 v[64:79], v[200:203], a[104:107], v[64:79]
    s_add_u32 s64, s82, 73728
    buffer_load_dwordx4 a[16:19], v4, s[40:43], s64 offen sc1
    ds_read_b64_tr_b16 v[192:193], v38 offset:10240
    v_mfma_f32_32x32x16_bf16 v[80:95], v[204:207], a[104:107], v[80:95]
    ds_read_b64_tr_b16 v[194:195], v38 offset:11264
    v_mfma_f32_32x32x16_bf16 v[96:111], v[200:203], a[108:111], v[96:111]
    s_add_u32 s64, s83, 73728
    buffer_load_dwordx4 a[20:23], v4, s[40:43], s64 offen sc1
    ds_read_b64_tr_b16 v[196:197], v39 offset:10240
    v_mfma_f32_32x32x16_bf16 v[112:127], v[204:207], a[108:111], v[112:127]
    ds_read_b64_tr_b16 v[198:199], v39 offset:11264
    s_waitcnt lgkmcnt(4)
    s_waitcnt vmcnt(8)
    v_mfma_f32_32x32x16_bf16 v[64:79], v[216:219], a[112:115], v[64:79]
    s_add_u32 s64, s82, 74752
    buffer_load_dwordx4 a[24:27], v4, s[40:43], s64 offen sc1
    ds_read_b64_tr_b16 v[200:201], v38 offset:12288
    v_mfma_f32_32x32x16_bf16 v[80:95], v[220:223], a[112:115], v[80:95]
    ds_read_b64_tr_b16 v[202:203], v38 offset:13312
    v_mfma_f32_32x32x16_bf16 v[96:111], v[216:219], a[116:119], v[96:111]
    s_add_u32 s64, s83, 74752
    buffer_load_dwordx4 a[28:31], v4, s[40:43], s64 offen sc1
    ds_read_b64_tr_b16 v[204:205], v39 offset:12288
    v_mfma_f32_32x32x16_bf16 v[112:127], v[220:223], a[116:119], v[112:127]
    ds_read_b64_tr_b16 v[206:207], v39 offset:13312
    s_waitcnt lgkmcnt(4)
    s_waitcnt vmcnt(8)
    v_mfma_f32_32x32x16_bf16 v[64:79], v[192:195], a[120:123], v[64:79]
    s_add_u32 s64, s82, 81920
    buffer_load_dwordx4 a[32:35], v4, s[40:43], s64 offen sc1
    ds_read_b64_tr_b16 v[216:217], v38 offset:14336
    v_mfma_f32_32x32x16_bf16 v[80:95], v[196:199], a[120:123], v[80:95]
    ds_read_b64_tr_b16 v[218:219], v38 offset:15360
    v_mfma_f32_32x32x16_bf16 v[96:111], v[192:195], a[124:127], v[96:111]
    s_add_u32 s64, s83, 81920
    buffer_load_dwordx4 a[36:39], v4, s[40:43], s64 offen sc1
    ds_read_b64_tr_b16 v[220:221], v39 offset:14336
    v_mfma_f32_32x32x16_bf16 v[112:127], v[196:199], a[124:127], v[112:127]
    ds_read_b64_tr_b16 v[222:223], v39 offset:15360
    s_waitcnt lgkmcnt(4)
    s_waitcnt vmcnt(8)
    v_mfma_f32_32x32x16_bf16 v[64:79], v[200:203], a[0:3], v[64:79]
    s_add_u32 s64, s82, 82944
    buffer_load_dwordx4 a[40:43], v4, s[40:43], s64 offen sc1
    ds_read_b64_tr_b16 v[192:193], v42 offset:0
    v_mfma_f32_32x32x16_bf16 v[80:95], v[204:207], a[0:3], v[80:95]
    ds_read_b64_tr_b16 v[194:195], v42 offset:1024
    v_mfma_f32_32x32x16_bf16 v[96:111], v[200:203], a[4:7], v[96:111]
    s_add_u32 s64, s83, 82944
    buffer_load_dwordx4 a[44:47], v4, s[40:43], s64 offen sc1
    ds_read_b64_tr_b16 v[196:197], v43 offset:0
    v_mfma_f32_32x32x16_bf16 v[112:127], v[204:207], a[4:7], v[112:127]
    ds_read_b64_tr_b16 v[198:199], v43 offset:1024
    s_waitcnt lgkmcnt(4)
    s_waitcnt vmcnt(8)
    v_mfma_f32_32x32x16_bf16 v[64:79], v[216:219], a[8:11], v[64:79]
    s_add_u32 s64, s82, 90112
    buffer_load_dwordx4 a[48:51], v4, s[40:43], s64 offen sc1
    ds_read_b64_tr_b16 v[200:201], v42 offset:2048
    v_mfma_f32_32x32x16_bf16 v[80:95], v[220:223], a[8:11], v[80:95]
    ds_read_b64_tr_b16 v[202:203], v42 offset:3072
    v_mfma_f32_32x32x16_bf16 v[96:111], v[216:219], a[12:15], v[96:111]
    s_add_u32 s64, s83, 90112
    buffer_load_dwordx4 a[52:55], v4, s[40:43], s64 offen sc1
    ds_read_b64_tr_b16 v[204:205], v43 offset:2048
    v_mfma_f32_32x32x16_bf16 v[112:127], v[220:223], a[12:15], v[112:127]
    ds_read_b64_tr_b16 v[206:207], v43 offset:3072
    s_waitcnt lgkmcnt(4)
    s_waitcnt vmcnt(8)
    v_mfma_f32_32x32x16_bf16 v[64:79], v[192:195], a[16:19], v[64:79]
    s_add_u32 s64, s82, 91136
    buffer_load_dwordx4 a[56:59], v4, s[40:43], s64 offen sc1
    ds_read_b64_tr_b16 v[216:217], v40 offset:0
    v_mfma_f32_32x32x16_bf16 v[80:95], v[196:199], a[16:19], v[80:95]
    ds_read_b64_tr_b16 v[218:219], v40 offset:1024
    v_mfma_f32_32x32x16_bf16 v[96:111], v[192:195], a[20:23], v[96:111]
    s_add_u32 s64, s83, 91136
    buffer_load_dwordx4 a[60:63], v4, s[40:43], s64 offen sc1
    ds_read_b64_tr_b16 v[220:221], v41 offset:0
    v_mfma_f32_32x32x16_bf16 v[112:127], v[196:199], a[20:23], v[112:127]
    ds_read_b64_tr_b16 v[222:223], v41 offset:1024
    s_waitcnt lgkmcnt(4)
    s_waitcnt vmcnt(8)
    v_mfma_f32_32x32x16_bf16 v[64:79], v[200:203], a[24:27], v[64:79]
    s_add_u32 s64, s82, 98304
    buffer_load_dwordx4 a[64:67], v4, s[40:43], s64 offen sc1
    ds_read_b64_tr_b16 v[192:193], v40 offset:2048
    v_mfma_f32_32x32x16_bf16 v[80:95], v[204:207], a[24:27], v[80:95]
    ds_read_b64_tr_b16 v[194:195], v40 offset:3072
    v_mfma_f32_32x32x16_bf16 v[96:111], v[200:203], a[28:31], v[96:111]
    s_add_u32 s64, s83, 98304
    buffer_load_dwordx4 a[68:71], v4, s[40:43], s64 offen sc1
    ds_read_b64_tr_b16 v[196:197], v41 offset:2048
    v_mfma_f32_32x32x16_bf16 v[112:127], v[204:207], a[28:31], v[112:127]
    ds_read_b64_tr_b16 v[198:199], v41 offset:3072
    s_waitcnt lgkmcnt(4)
    s_waitcnt vmcnt(8)
    v_mfma_f32_32x32x16_bf16 v[64:79], v[216:219], a[32:35], v[64:79]
    s_add_u32 s64, s82, 99328
    buffer_load_dwordx4 a[72:75], v4, s[40:43], s64 offen sc1
    ds_read_b64_tr_b16 v[200:201], v40 offset:4096
    v_mfma_f32_32x32x16_bf16 v[80:95], v[220:223], a[32:35], v[80:95]
    ds_read_b64_tr_b16 v[202:203], v40 offset:5120
    v_mfma_f32_32x32x16_bf16 v[96:111], v[216:219], a[36:39], v[96:111]
    s_add_u32 s64, s83, 99328
    buffer_load_dwordx4 a[76:79], v4, s[40:43], s64 offen sc1
    ds_read_b64_tr_b16 v[204:205], v41 offset:4096
    v_mfma_f32_32x32x16_bf16 v[112:127], v[220:223], a[36:39], v[112:127]
    ds_read_b64_tr_b16 v[206:207], v41 offset:5120
    s_waitcnt lgkmcnt(4)
    s_waitcnt vmcnt(8)
    v_mfma_f32_32x32x16_bf16 v[64:79], v[192:195], a[40:43], v[64:79]
    s_add_u32 s64, s82, 106496
    buffer_load_dwordx4 a[80:83], v4, s[40:43], s64 offen sc1
    ds_read_b64_tr_b16 v[216:217], v40 offset:6144
    v_mfma_f32_32x32x16_bf16 v[80:95], v[196:199], a[40:43], v[80:95]
    ds_read_b64_tr_b16 v[218:219], v40 offset:7168
    v_mfma_f32_32x32x16_bf16 v[96:111], v[192:195], a[44:47], v[96:111]
    s_add_u32 s64, s83, 106496
    buffer_load_dwordx4 a[84:87], v4, s[40:43], s64 offen sc1
    ds_read_b64_tr_b16 v[220:221], v41 offset:6144
    v_mfma_f32_32x32x16_bf16 v[112:127], v[196:199], a[44:47], v[112:127]
    ds_read_b64_tr_b16 v[222:223], v41 offset:7168
    s_waitcnt lgkmcnt(4)
    s_waitcnt vmcnt(8)
    v_mfma_f32_32x32x16_bf16 v[64:79], v[200:203], a[48:51], v[64:79]
    s_add_u32 s64, s82, 107520
    buffer_load_dwordx4 a[88:91], v4, s[40:43], s64 offen sc1
    ds_read_b64_tr_b16 v[192:193], v40 offset:8192
    v_mfma_f32_32x32x16_bf16 v[80:95], v[204:207], a[48:51], v[80:95]
    ds_read_b64_tr_b16 v[194:195], v40 offset:9216
    v_mfma_f32_32x32x16_bf16 v[96:111], v[200:203], a[52:55], v[96:111]
    s_add_u32 s64, s83, 107520
    buffer_load_dwordx4 a[92:95], v4, s[40:43], s64 offen sc1
    ds_read_b64_tr_b16 v[196:197], v41 offset:8192
    v_mfma_f32_32x32x16_bf16 v[112:127], v[204:207], a[52:55], v[112:127]
    ds_read_b64_tr_b16 v[198:199], v41 offset:9216
    s_waitcnt lgkmcnt(4)
    s_waitcnt vmcnt(8)
    v_mfma_f32_32x32x16_bf16 v[64:79], v[216:219], a[56:59], v[64:79]
    ds_read_b64_tr_b16 v[200:201], v40 offset:10240
    v_mfma_f32_32x32x16_bf16 v[80:95], v[220:223], a[56:59], v[80:95]
    ds_read_b64_tr_b16 v[202:203], v40 offset:11264
    v_mfma_f32_32x32x16_bf16 v[96:111], v[216:219], a[60:63], v[96:111]
    ds_read_b64_tr_b16 v[204:205], v41 offset:10240
    v_mfma_f32_32x32x16_bf16 v[112:127], v[220:223], a[60:63], v[112:127]
    ds_read_b64_tr_b16 v[206:207], v41 offset:11264
    s_waitcnt lgkmcnt(4)
    s_waitcnt vmcnt(6)
    v_mfma_f32_32x32x16_bf16 v[64:79], v[192:195], a[64:67], v[64:79]
    ds_read_b64_tr_b16 v[216:217], v40 offset:12288
    v_mfma_f32_32x32x16_bf16 v[80:95], v[196:199], a[64:67], v[80:95]
    ds_read_b64_tr_b16 v[218:219], v40 offset:13312
    v_mfma_f32_32x32x16_bf16 v[96:111], v[192:195], a[68:71], v[96:111]
    ds_read_b64_tr_b16 v[220:221], v41 offset:12288
    v_mfma_f32_32x32x16_bf16 v[112:127], v[196:199], a[68:71], v[112:127]
    ds_read_b64_tr_b16 v[222:223], v41 offset:13312
    s_waitcnt lgkmcnt(4)
    s_waitcnt vmcnt(4)
    v_mfma_f32_32x32x16_bf16 v[64:79], v[200:203], a[72:75], v[64:79]
    ds_read_b64_tr_b16 v[192:193], v40 offset:14336
    v_mfma_f32_32x32x16_bf16 v[80:95], v[204:207], a[72:75], v[80:95]
    ds_read_b64_tr_b16 v[194:195], v40 offset:15360
    v_mfma_f32_32x32x16_bf16 v[96:111], v[200:203], a[76:79], v[96:111]
    ds_read_b64_tr_b16 v[196:197], v41 offset:14336
    v_mfma_f32_32x32x16_bf16 v[112:127], v[204:207], a[76:79], v[112:127]
    ds_read_b64_tr_b16 v[198:199], v41 offset:15360
    s_waitcnt lgkmcnt(4)
    s_waitcnt vmcnt(2)
    v_mfma_f32_32x32x16_bf16 v[64:79], v[216:219], a[80:83], v[64:79]
    v_mfma_f32_32x32x16_bf16 v[80:95], v[220:223], a[80:83], v[80:95]
    v_mfma_f32_32x32x16_bf16 v[96:111], v[216:219], a[84:87], v[96:111]
    v_mfma_f32_32x32x16_bf16 v[112:127], v[220:223], a[84:87], v[112:127]
    s_waitcnt lgkmcnt(0)
    s_waitcnt vmcnt(0)
    v_mfma_f32_32x32x16_bf16 v[64:79], v[192:195], a[88:91], v[64:79]
    v_mfma_f32_32x32x16_bf16 v[80:95], v[196:199], a[88:91], v[80:95]
    v_mfma_f32_32x32x16_bf16 v[96:111], v[192:195], a[92:95], v[96:111]
    v_mfma_f32_32x32x16_bf16 v[112:127], v[196:199], a[92:95], v[112:127]
    s_nop 8
    v_pk_fma_f32 v[64:65], v[64:65], v[212:213], v[128:129] op_sel_hi:[1,0,1]
    v_pk_fma_f32 v[66:67], v[66:67], v[212:213], v[130:131] op_sel_hi:[1,0,1]
    v_pk_fma_f32 v[68:69], v[68:69], v[212:213], v[132:133] op_sel_hi:[1,0,1]
    v_pk_fma_f32 v[70:71], v[70:71], v[212:213], v[134:135] op_sel_hi:[1,0,1]
    v_pk_fma_f32 v[72:73], v[72:73], v[212:213], v[136:137] op_sel_hi:[1,0,1]
    v_pk_fma_f32 v[74:75], v[74:75], v[212:213], v[138:139] op_sel_hi:[1,0,1]
    v_pk_fma_f32 v[76:77], v[76:77], v[212:213], v[140:141] op_sel_hi:[1,0,1]
    v_pk_fma_f32 v[78:79], v[78:79], v[212:213], v[142:143] op_sel_hi:[1,0,1]
    v_pk_fma_f32 v[80:81], v[80:81], v[212:213], v[144:145] op_sel_hi:[1,0,1]
    v_pk_fma_f32 v[82:83], v[82:83], v[212:213], v[146:147] op_sel_hi:[1,0,1]
    v_pk_fma_f32 v[84:85], v[84:85], v[212:213], v[148:149] op_sel_hi:[1,0,1]
    v_pk_fma_f32 v[86:87], v[86:87], v[212:213], v[150:151] op_sel_hi:[1,0,1]
    v_pk_fma_f32 v[88:89], v[88:89], v[212:213], v[152:153] op_sel_hi:[1,0,1]
    v_pk_fma_f32 v[90:91], v[90:91], v[212:213], v[154:155] op_sel_hi:[1,0,1]
    v_pk_fma_f32 v[92:93], v[92:93], v[212:213], v[156:157] op_sel_hi:[1,0,1]
    v_pk_fma_f32 v[94:95], v[94:95], v[212:213], v[158:159] op_sel_hi:[1,0,1]
    v_pk_fma_f32 v[96:97], v[96:97], v[214:215], v[160:161] op_sel_hi:[1,0,1]
    v_pk_fma_f32 v[98:99], v[98:99], v[214:215], v[162:163] op_sel_hi:[1,0,1]
    v_pk_fma_f32 v[100:101], v[100:101], v[214:215], v[164:165] op_sel_hi:[1,0,1]
    v_pk_fma_f32 v[102:103], v[102:103], v[214:215], v[166:167] op_sel_hi:[1,0,1]
    v_pk_fma_f32 v[104:105], v[104:105], v[214:215], v[168:169] op_sel_hi:[1,0,1]
    v_pk_fma_f32 v[106:107], v[106:107], v[214:215], v[170:171] op_sel_hi:[1,0,1]
    v_pk_fma_f32 v[108:109], v[108:109], v[214:215], v[172:173] op_sel_hi:[1,0,1]
    v_pk_fma_f32 v[110:111], v[110:111], v[214:215], v[174:175] op_sel_hi:[1,0,1]
    v_pk_fma_f32 v[112:113], v[112:113], v[214:215], v[176:177] op_sel_hi:[1,0,1]
    v_pk_fma_f32 v[114:115], v[114:115], v[214:215], v[178:179] op_sel_hi:[1,0,1]
    v_pk_fma_f32 v[116:117], v[116:117], v[214:215], v[180:181] op_sel_hi:[1,0,1]
    v_pk_fma_f32 v[118:119], v[118:119], v[214:215], v[182:183] op_sel_hi:[1,0,1]
    v_pk_fma_f32 v[120:121], v[120:121], v[214:215], v[184:185] op_sel_hi:[1,0,1]
    v_pk_fma_f32 v[122:123], v[122:123], v[214:215], v[186:187] op_sel_hi:[1,0,1]
    v_pk_fma_f32 v[124:125], v[124:125], v[214:215], v[188:189] op_sel_hi:[1,0,1]
    v_pk_fma_f32 v[126:127], v[126:127], v[214:215], v[190:191] op_sel_hi:[1,0,1]
    s_lshl_b32 s56, s48, 14
    v_add_u32 v46, s56, v4
    ds_write_b128 v46, v[80:83] offset:0
    ds_write_b128 v46, v[84:87] offset:1024
    ds_write_b128 v46, v[88:91] offset:2048
    ds_write_b128 v46, v[92:95] offset:3072
    ds_write_b128 v46, v[96:99] offset:4096
    ds_write_b128 v46, v[100:103] offset:5120
    ds_write_b128 v46, v[104:107] offset:6144
    ds_write_b128 v46, v[108:111] offset:7168
    ds_write_b128 v46, v[112:115] offset:8192
    ds_write_b128 v46, v[116:119] offset:9216
    ds_write_b128 v46, v[120:123] offset:10240
    ds_write_b128 v46, v[124:127] offset:11264
    s_xor_b32 s56, s48, 1
    s_lshl_b32 s56, s56, 14
    v_add_u32 v47, s56, v4
    s_xor_b32 s56, s48, 2
    s_lshl_b32 s56, s56, 14
    v_add_u32 v48, s56, v4
    s_xor_b32 s56, s48, 3
    s_lshl_b32 s56, s56, 14
    v_add_u32 v49, s56, v4
    s_waitcnt lgkmcnt(0)
    s_barrier
    ds_read_b128 v[80:83], v47 offset:0
    ds_read_b128 v[84:87], v47 offset:1024
    ds_read_b128 v[88:91], v47 offset:2048
    ds_read_b128 v[92:95], v47 offset:3072
    ds_read_b128 v[96:99], v48 offset:4096
    ds_read_b128 v[100:103], v48 offset:5120
    ds_read_b128 v[104:107], v48 offset:6144
    ds_read_b128 v[108:111], v48 offset:7168
    ds_read_b128 v[112:115], v49 offset:8192
    ds_read_b128 v[116:119], v49 offset:9216
    ds_read_b128 v[120:123], v49 offset:10240
    ds_read_b128 v[124:127], v49 offset:11264
    s_waitcnt lgkmcnt(8)
    v_pk_add_f32 v[64:65], v[64:65], v[80:81]
    v_pk_add_f32 v[66:67], v[66:67], v[82:83]
    v_pk_add_f32 v[68:69], v[68:69], v[84:85]
    v_pk_add_f32 v[70:71], v[70:71], v[86:87]
    v_pk_add_f32 v[72:73], v[72:73], v[88:89]
    v_pk_add_f32 v[74:75], v[74:75], v[90:91]
    v_pk_add_f32 v[76:77], v[76:77], v[92:93]
    v_pk_add_f32 v[78:79], v[78:79], v[94:95]
    s_waitcnt lgkmcnt(4)
    v_pk_add_f32 v[64:65], v[64:65], v[96:97]
    v_pk_add_f32 v[66:67], v[66:67], v[98:99]
    v_pk_add_f32 v[68:69], v[68:69], v[100:101]
    v_pk_add_f32 v[70:71], v[70:71], v[102:103]
    v_pk_add_f32 v[72:73], v[72:73], v[104:105]
    v_pk_add_f32 v[74:75], v[74:75], v[106:107]
    v_pk_add_f32 v[76:77], v[76:77], v[108:109]
    v_pk_add_f32 v[78:79], v[78:79], v[110:111]
    s_waitcnt lgkmcnt(0)
    v_pk_add_f32 v[64:65], v[64:65], v[112:113]
    v_pk_add_f32 v[66:67], v[66:67], v[114:115]
    v_pk_add_f32 v[68:69], v[68:69], v[116:117]
    v_pk_add_f32 v[70:71], v[70:71], v[118:119]
    v_pk_add_f32 v[72:73], v[72:73], v[120:121]
    v_pk_add_f32 v[74:75], v[74:75], v[122:123]
    v_pk_add_f32 v[76:77], v[76:77], v[124:125]
    v_pk_add_f32 v[78:79], v[78:79], v[126:127]
    v_lshlrev_b32 v54, 16, v30
    v_and_b32 v55, 0xffff0000, v30
    v_pk_fma_f32 v[64:65], v[54:55], v[212:213], v[64:65] op_sel_hi:[1,0,1]
    v_cvt_pk_bf16_f32 v128, v64, v65
    v_lshlrev_b32 v54, 16, v31
    v_and_b32 v55, 0xffff0000, v31
    v_pk_fma_f32 v[66:67], v[54:55], v[212:213], v[66:67] op_sel_hi:[1,0,1]
    v_cvt_pk_bf16_f32 v129, v66, v67
    v_lshlrev_b32 v54, 16, v32
    v_and_b32 v55, 0xffff0000, v32
    v_pk_fma_f32 v[68:69], v[54:55], v[212:213], v[68:69] op_sel_hi:[1,0,1]
    v_cvt_pk_bf16_f32 v130, v68, v69
    v_lshlrev_b32 v54, 16, v33
    v_and_b32 v55, 0xffff0000, v33
    v_pk_fma_f32 v[70:71], v[54:55], v[212:213], v[70:71] op_sel_hi:[1,0,1]
    v_cvt_pk_bf16_f32 v131, v70, v71
    v_lshlrev_b32 v54, 16, v34
    v_and_b32 v55, 0xffff0000, v34
    v_pk_fma_f32 v[72:73], v[54:55], v[212:213], v[72:73] op_sel_hi:[1,0,1]
    v_cvt_pk_bf16_f32 v132, v72, v73
    v_lshlrev_b32 v54, 16, v35
    v_and_b32 v55, 0xffff0000, v35
    v_pk_fma_f32 v[74:75], v[54:55], v[212:213], v[74:75] op_sel_hi:[1,0,1]
    v_cvt_pk_bf16_f32 v133, v74, v75
    v_lshlrev_b32 v54, 16, v36
    v_and_b32 v55, 0xffff0000, v36
    v_pk_fma_f32 v[76:77], v[54:55], v[212:213], v[76:77] op_sel_hi:[1,0,1]
    v_cvt_pk_bf16_f32 v134, v76, v77
    v_lshlrev_b32 v54, 16, v37
    v_and_b32 v55, 0xffff0000, v37
    v_pk_fma_f32 v[78:79], v[54:55], v[212:213], v[78:79] op_sel_hi:[1,0,1]
    v_cvt_pk_bf16_f32 v135, v78, v79
    v_permlane32_swap_b32 v128, v130
    v_permlane32_swap_b32 v129, v131
    v_permlane32_swap_b32 v132, v134
    v_permlane32_swap_b32 v133, v135
    s_lshl_b32 s58, s49, 6
    s_lshl_b32 s59, s90, 5
    s_add_u32 s58, s58, s59
    v_add_u32 v54, s58, v2
    v_lshlrev_b32 v54, 10, v54
    s_lshl_b32 s58, s50, 7
    s_lshl_b32 s59, s91, 6
    s_add_u32 s58, s58, s59
    v_lshlrev_b32 v55, 4, v3
    v_add3_u32 v54, v54, v55, s58
    buffer_store_dwordx4 v[128:131], v54, s[36:39], 0 offen offset:0
    buffer_store_dwordx4 v[132:135], v54, s[36:39], 0 offen offset:32
    s_waitcnt vmcnt(0)
    s_nop 0
L_end:
    s_endpgm
L_codeend:
.section .rodata,"a"
.p2align 6
.amdhsa_kernel gated_mix__linear_attn_block__mixer_s_mlp__prompt_kernel
  .amdhsa_next_free_vgpr 512
  .amdhsa_next_free_sgpr 102
  .amdhsa_accum_offset 256
  .amdhsa_group_segment_fixed_size 0
  .amdhsa_kernarg_size 96
  .amdhsa_user_sgpr_count 2
  .amdhsa_user_sgpr_kernarg_segment_ptr 1
  .amdhsa_system_sgpr_workgroup_id_x 1
  .amdhsa_float_denorm_mode_32 3
  .amdhsa_float_denorm_mode_16_64 3
.end_amdhsa_kernel
```
